```python
import torch

def _softmax(x, axis=-1):
    return torch.softmax(x, dim=axis)
def _gelu(x):
    return torch.nn.functional.gelu(x, approximate="tanh")
def _silu(x):
    return torch.nn.functional.silu(x)
def _sigmoid(x):
    return torch.sigmoid(x)
def _layernorm(x, axis=-1, eps=1e-5):
    m = x.mean(dim=axis, keepdim=True)
    v = x.var(dim=axis, keepdim=True, unbiased=False)
    return (x - m) / torch.sqrt(v + eps)
def _scatter_add(tgt, idx, src, axis=0):
    return tgt.clone().index_add_(axis, idx, src)
def _segment_sum(src, seg, n):
    out = torch.zeros((n,) + src.shape[1:], dtype=src.dtype)
    return out.index_add_(0, seg, src)
def _pad(x, pw):
    flat = tuple(v for pair in reversed(pw) for v in pair)
    return torch.nn.functional.pad(x, flat)

kernel_name = 'concat_heads__ssm_conv_s5__linear_kernel_hedgehog__prompt'

def setup_inputs():

    _w = (lambda a: (lambda t: t.to(torch.bfloat16) if t.is_floating_point() else t)(torch.as_tensor(a)))
    def _A_setup():
        B, S, D = 1, 2048, 512
        P = D
        Lambda_re = -0.5 * (lambda _x: torch.exp(torch.as_tensor(_x)))((lambda *s: torch.randn(*s, dtype=torch.bfloat16) * 0.8)(P))
        Lambda_im = (lambda *s: torch.randn(*s, dtype=torch.bfloat16) * 0.8)(P) * 1.0
        B_re = (lambda *s: torch.randn(*s, dtype=torch.bfloat16) * 0.8)(P, D) * (D ** -0.5)
        B_im = (lambda *s: torch.randn(*s, dtype=torch.bfloat16) * 0.8)(P, D) * (D ** -0.5)
        C_re = (lambda *s: torch.randn(*s, dtype=torch.bfloat16) * 0.8)(D, P) * (P ** -0.5)
        C_im = (lambda *s: torch.randn(*s, dtype=torch.bfloat16) * 0.8)(D, P) * (P ** -0.5)
        log_dt = (lambda *s: torch.randn(*s, dtype=torch.bfloat16) * 0.8)(P) * 0.3 - 2.0
        Dskip = (lambda *s: torch.randn(*s, dtype=torch.bfloat16) * 0.8)(D)
        return {
            "x": _w((lambda *s: torch.randn(*s, dtype=torch.bfloat16) * 0.05)(B, S, D)),
            "Lambda_re": _w(Lambda_re),
            "Lambda_im": _w(Lambda_im),
            "B_re": _w(B_re),
            "B_im": _w(B_im),
            "C_re": _w(C_re),
            "C_im": _w(C_im),
            "log_dt": _w(log_dt),
            "Dskip": _w(Dskip),
        }
    _A_in = _A_setup()

    def _B_setup():
        B, S, D, H = 1, 2048, 512, 32
        Dh = D // H
        return {
            "x": _w((lambda *s: torch.randn(*s, dtype=torch.bfloat16) * 0.4)(B, S, D)),
            "wqkv": _w((lambda *s: torch.randn(*s, dtype=torch.bfloat16) * 0.4)(D, 3 * D)),
            "w_phi": _w((lambda *s: torch.randn(*s, dtype=torch.bfloat16) * 0.4)(H, Dh, Dh) * (Dh ** -0.5)),
            "wo": _w((lambda *s: torch.randn(*s, dtype=torch.bfloat16) * 0.05)(D, D)),
        }
    _B_in = _B_setup()

    return {
        "A_x": _A_in["x"],
        "A_Lambda_re": _A_in["Lambda_re"],
        "A_Lambda_im": _A_in["Lambda_im"],
        "A_B_re": _A_in["B_re"],
        "A_B_im": _A_in["B_im"],
        "A_C_re": _A_in["C_re"],
        "A_C_im": _A_in["C_im"],
        "A_log_dt": _A_in["log_dt"],
        "A_Dskip": _A_in["Dskip"],
        "B_x": _B_in["x"],
        "B_wqkv": _B_in["wqkv"],
        "B_w_phi": _B_in["w_phi"],
        "B_wo": _B_in["wo"],
    }

def reference(A_x, A_Lambda_re, A_Lambda_im, A_B_re, A_B_im, A_C_re, A_C_im, A_log_dt, A_Dskip, B_x, B_wqkv, B_w_phi, B_wo):
    def _A_ref(x, Lambda_re, Lambda_im, B_re, B_im, C_re, C_im, log_dt, Dskip):
        Bsz, L, H = x.shape
        Lam = Lambda_re + 1j * Lambda_im
        Bmat = B_re + 1j * B_im
        Cmat = C_re + 1j * C_im
        dt = torch.exp(log_dt)
        Lam_bar = torch.exp(dt * Lam)
        B_bar = ((Lam_bar - 1.0) / Lam)[:, None] * Bmat
        Bu = torch.einsum("bld,pd->blp", x + 0j, B_bar)
        h = torch.zeros_like(Bu[:, 0, :])
        hs = []
        for t in range(L):
            h = Lam_bar[None, :] * h + Bu[:, t, :]
            hs.append(h)
        hseq = torch.stack(hs, 1)
        y = 2.0 * torch.einsum("blp,dp->bld", hseq, Cmat).real + x * Dskip[None, None, :]
        return y

    def _B_ref(x, wqkv, w_phi, wo):
        B, S, D = x.shape
        H = 32; Dh = D // H
        qkv = (lambda x, *d: x.permute(*d))((x @ wqkv).reshape(B, S, 3, H, Dh), 2, 0, 3, 1, 4)
        q, k, v = qkv[0], qkv[1], qkv[2]
        pq = torch.einsum("bhsd,hdf->bhsf", q, w_phi)
        pk = torch.einsum("bhsd,hdf->bhsf", k, w_phi)
        phi_q = torch.concatenate([_softmax(pq, axis=-1), _softmax(-pq, axis=-1)], axis=-1)
        phi_k = torch.concatenate([_softmax(pk, axis=-1), _softmax(-pk, axis=-1)], axis=-1)
        kv = torch.einsum("bhsf,bhsd->bhfd", phi_k, v)
        z  = torch.einsum("bhsf->bhf", phi_k)
        num = torch.einsum("bhqf,bhfd->bhqd", phi_q, kv)
        den = torch.einsum("bhqf,bhf->bhq", phi_q, z)[..., None] + 1e-6
        o = num / den
        return (lambda x, *d: x.permute(*d))(o, 0, 2, 1, 3).reshape(B, S, D) @ wo

    a = _A_ref(A_x, A_Lambda_re, A_Lambda_im, A_B_re, A_B_im, A_C_re, A_C_im, A_log_dt, A_Dskip)
    b = _B_ref(B_x, B_wqkv, B_w_phi, B_wo)
    return torch.concatenate([a, b], axis=-1)
```

```asm
; @launch grid=(256,1,1) block=(256,1,1) lds=163840
.amdgcn_target "amdgcn-amd-amdhsa--gfx950"
.text
.globl concat_heads__ssm_conv_s5__linear_kernel_hedgehog__prompt_kernel
.p2align 8
.type concat_heads__ssm_conv_s5__linear_kernel_hedgehog__prompt_kernel,@function
concat_heads__ssm_conv_s5__linear_kernel_hedgehog__prompt_kernel:
    s_getpc_b64 s[52:53]
L_pc:
    s_cmp_ge_u32 s2, 256
    s_cbranch_scc1 L_end
    s_bitcmp1_b32 s2, 0
    s_cselect_b32 s56, 72, 0
    s_cselect_b32 s57, 80, 24
    s_load_dwordx2 s[24:25], s[0:1], s56
    s_load_dwordx2 s[28:29], s[0:1], s57
    s_cselect_b32 s58, 80, 32
    s_load_dwordx2 s[32:33], s[0:1], s58
    s_load_dwordx2 s[36:37], s[0:1], 120
    s_cselect_b32 s56, 0, L_role2-L_pc
    s_mov_b32 s57, L_codeend-L_pc-4
    s_cselect_b32 s57, L_role2-L_pc-4, s57
    s_lshr_b32 s58, s2, 3
    s_lshl_b32 s58, s58, 10
    s_add_u32 s56, s56, s58
    v_lshrrev_b32 v2, 6, v0
    v_and_b32 v1, 63, v0
    v_lshlrev_b32 v3, 8, v2
    v_lshl_add_u32 v3, v1, 7, v3
    v_add_u32 v3, s56, v3
    v_min_u32 v3, s57, v3
    s_mov_b64 exec, 3
    global_load_dword v27, v3, s[52:53]
    s_mov_b64 exec, -1
    v_readfirstlane_b32 s20, v2
    s_lshr_b32 s21, s2, 1
    s_and_b32 s21, s21, 3
    s_lshr_b32 s22, s2, 3
    s_lshl_b32 s50, s21, 2
    s_and_b32 s52, s22, 3
    s_add_u32 s50, s50, s52
    s_lshr_b32 s51, s22, 2
    s_add_u32 s55, s52, s51
    s_and_b32 s55, s55, 3
    s_lshl_b32 s55, s55, 1
    v_lshrrev_b32 v2, 5, v1
    v_lshlrev_b32 v2, 5, v2
    v_bfe_u32 v3, v1, 3, 1
    v_lshl_add_u32 v2, v3, 4, v2
    v_bfe_u32 v5, v1, 4, 1
    v_add_u32 v2, v2, v5
    v_lshlrev_b32 v2, 10, v2
    v_and_b32 v3, 7, v1
    v_lshrrev_b32 v4, 4, v1
    v_lshlrev_b32 v5, 2, v5
    v_xor_b32 v5, v3, v5
    v_xor_b32 v3, v3, v4
    v_lshlrev_b32 v3, 4, v3
    v_lshlrev_b32 v4, 4, v5
    s_lshr_b32 s52, s20, 1
    s_lshl_b32 s52, s52, 6
    s_and_b32 s53, s20, 1
    s_lshl_b32 s53, s53, 3
    s_add_u32 s52, s52, s53
    s_lshl_b32 s53, s50, 7
    s_add_u32 s46, s52, s53
    s_lshl_b32 s52, s46, 10
    v_add3_u32 v10, v2, v3, s52
    v_xor_b32 v11, 64, v10
    v_add_u32 v11, 2048, v11
    v_add_u32 v12, 4096, v10
    v_add_u32 v13, 4096, v11
    s_lshl_b32 s60, s20, 12
    s_lshl_b32 s61, s20, 11
    s_mov_b32 s26, 2097152
    s_mov_b32 s27, 0x20000
    s_and_b32 s56, s55, 7
    s_lshl_b32 s4, s56, 7
    s_waitcnt lgkmcnt(0)
    s_add_u32 m0, s60, 0
    s_nop 0
    buffer_load_dwordx4 v10, s[24:27], s4 offen lds
    s_add_u32 m0, s60, 1024
    s_nop 0
    buffer_load_dwordx4 v11, s[24:27], s4 offen lds
    s_add_u32 m0, s60, 2048
    s_nop 0
    buffer_load_dwordx4 v12, s[24:27], s4 offen lds
    s_add_u32 m0, s60, 3072
    s_nop 0
    buffer_load_dwordx4 v13, s[24:27], s4 offen lds
    s_mov_b32 s31, 0x20000
    s_mov_b32 s35, 0x20000
    s_mov_b32 s30, 524288
    s_movk_i32 s48, 1024
    s_mov_b32 s49, 65536
    s_movk_i32 s58, 128
    s_bitcmp1_b32 s2, 0
    s_cselect_b64 vcc, -1, 0
    s_cselect_b32 s30, 1572864, s30
    s_cselect_b32 s54, s48, 0
    s_cselect_b32 s48, 3072, s48
    s_cselect_b32 s49, s58, s49
    s_cselect_b32 s58, 196608, s58
    s_cselect_b32 s57, 0, 64
    s_mov_b32 s34, s30
    v_cndmask_b32 v3, v3, v4, vcc
    v_lshrrev_b32 v2, 3, v1
    v_mul_u32_u24 v5, s48, v2
    s_mul_i32 s52, s51, s49
    s_add_u32 s52, s52, s54
    s_lshl_b32 s53, s20, 4
    s_mul_i32 s53, s53, s48
    s_add_u32 s52, s52, s53
    s_lshl_b32 s53, s22, 2
    s_add_u32 s53, s53, s20
    s_lshl_b32 s53, s53, 2
    v_add_u32 v6, s53, v1
    v_mul_u32_u24 v6, s48, v6
    s_lshl_b32 s53, s54, 1
    s_mov_b64 exec, 15
    buffer_load_dword v27, v6, s[28:31], s54 offen offset:384
    buffer_load_dword v27, v6, s[32:35], s53 offen offset:384
    s_mov_b64 exec, -1
    s_lshl_b32 s48, s48, 3
    v_add3_u32 v14, v3, v5, s52
    v_xor_b32 v15, s57, v14
    v_add_u32 v15, s48, v15
    v_add_u32 v16, s54, v14
    v_add_u32_e64 v17, s54, v15
    s_add_u32 s56, s55, 0
    s_and_b32 s56, s56, 7
    s_lshl_b32 s4, s56, 7
    s_mul_i32 s12, s56, s58
    s_add_u32 s56, s55, 1
    s_and_b32 s56, s56, 7
    s_lshl_b32 s5, s56, 7
    s_mul_i32 s13, s56, s58
    s_waitcnt lgkmcnt(0)
    s_add_u32 m0, s61, 16384
    s_nop 0
    buffer_load_dwordx4 v14, s[28:31], s12 offen lds
    s_add_u32 m0, s61, 17408
    s_nop 0
    buffer_load_dwordx4 v15, s[28:31], s12 offen lds
    s_add_u32 m0, s61, 24576
    s_nop 0
    buffer_load_dwordx4 v16, s[32:35], s12 offen lds
    s_add_u32 m0, s61, 25600
    s_nop 0
    buffer_load_dwordx4 v17, s[32:35], s12 offen lds
    s_add_u32 m0, s60, 32768
    s_nop 0
    buffer_load_dwordx4 v10, s[24:27], s5 offen lds
    s_add_u32 m0, s60, 33792
    s_nop 0
    buffer_load_dwordx4 v11, s[24:27], s5 offen lds
    s_add_u32 m0, s60, 34816
    s_nop 0
    buffer_load_dwordx4 v12, s[24:27], s5 offen lds
    s_bitcmp1_b32 s2, 0
    s_cbranch_scc0 L_role2
    s_load_dwordx2 s[96:97], s[0:1], 88
    s_load_dwordx2 s[92:93], s[0:1], 96
    s_load_dwordx2 s[40:41], s[0:1], 104
    v_lshl_add_u32 v25, v2, 10, v4
    v_subrev_u32 v18, 1024, v14
    v_subrev_u32 v19, 1024, v15
    v_and_b32 v9, 31, v1
    v_lshrrev_b32 v8, 5, v1
    s_and_b32 s63, s20, 1
    s_lshr_b32 s62, s20, 1
    s_lshl_b32 s48, s51, 2
    s_lshl_b32 s52, s63, 1
    s_add_u32 s48, s48, s52
    s_add_u32 s49, s48, s62
    v_lshlrev_b32 v26, 4, v1
    v_lshlrev_b32 v250, 2, v9
    s_mul_i32 s52, s49, 20480
    s_add_u32 s52, s52, 6422528
    s_lshl_b32 s54, s50, 10
    s_lshl_b32 s86, s50, 7
    s_add_u32 s86, s86, 16384
    v_mov_b32 v52, -1
    v_mov_b32 v53, -1
    v_mov_b32 v54, -1
    v_mov_b32 v55, -1
    s_add_u32 s64, s36, s52
    s_addc_u32 s65, s37, 0
    s_mov_b32 s66, 20480
    s_mov_b32 s67, 0x20000
    v_lshrrev_b32 v2, 3, v9
    v_and_b32 v3, 3, v9
    v_lshl_add_u32 v2, v2, 2, v3
    v_bfe_u32 v3, v1, 2, 1
    v_lshl_add_u32 v3, v3, 4, v2
    v_lshlrev_b32_e64 v244, 2, v3
    v_lshl_add_u32 v244, v8, 7, v244
    v_lshl_add_u32 v3, v8, 5, v3
    v_lshlrev_b32 v243, 4, v3
    s_lshl_b32 s84, s48, 9
    s_mov_b32 s98, 16384
    s_mov_b32 s99, 0x20000
    s_add_u32 s56, s55, 2
    s_and_b32 s56, s56, 7
    s_lshl_b32 s6, s56, 7
    s_mul_i32 s14, s56, 196608
    s_add_u32 s56, s55, 3
    s_and_b32 s56, s56, 7
    s_lshl_b32 s7, s56, 7
    s_mul_i32 s15, s56, 196608
    s_add_u32 s56, s55, 4
    s_and_b32 s56, s56, 7
    s_lshl_b32 s8, s56, 7
    s_mul_i32 s16, s56, 196608
    s_add_u32 s56, s55, 5
    s_and_b32 s56, s56, 7
    s_lshl_b32 s9, s56, 7
    s_mul_i32 s17, s56, 196608
    s_add_u32 s56, s55, 6
    s_and_b32 s56, s56, 7
    s_lshl_b32 s10, s56, 7
    s_mul_i32 s18, s56, 196608
    s_add_u32 s56, s55, 7
    s_and_b32 s56, s56, 7
    s_lshl_b32 s11, s56, 7
    s_mul_i32 s19, s56, 196608
    s_mov_b32 s38, 268435456
    s_mov_b32 s39, 0x20000
    s_mov_b32 s42, 8388608
    s_mov_b32 s43, 0x20000
    s_mov_b32 s94, 524288
    s_mov_b32 s95, 0x20000
    s_mov_b32 s68, 1069066811
    s_mov_b32 s69, 3216550459
    v_bfe_u32 v4, v1, 1, 3
    v_xor_b32 v4, v8, v4
    v_lshlrev_b32 v4, 4, v4
    v_lshl_add_u32 v4, v9, 7, v4
    s_lshl_b32 s52, s62, 13
    v_xor_b32 v5, 0, v4
    v_add_u32 v20, s52, v5
    v_xor_b32 v5, 32, v4
    v_add_u32 v21, s52, v5
    v_xor_b32 v5, 64, v4
    v_add_u32 v22, s52, v5
    v_xor_b32 v5, 96, v4
    v_add_u32 v23, s52, v5
    v_bfe_u32 v4, v1, 2, 2
    v_lshl_add_u32 v5, v8, 3, v4
    v_lshlrev_b32 v5, 7, v5
    v_lshrrev_b32 v6, 1, v4
    v_xor_b32_e64 v6, s63, v6
    v_lshl_add_u32 v5, v6, 6, v5
    v_bfe_u32 v6, v1, 4, 1
    v_lshl_add_u32 v5, v6, 5, v5
    v_and_b32_e64 v3, 3, v1
    v_lshl_add_u32 v63, v3, 3, v5
    s_xor_b32 s85, s62, 1
    s_lshl_b32 s52, s85, 5
    v_xor_b32 v240, s52, v63
    v_add_u32 v24, 16384, v240
    v_lshlrev_b32 v7, 1, v6
    v_bfe_u32 v2, v1, 1, 1
    v_add_u32 v7, v7, v2
    v_lshl_add_u32 v56, v8, 2, v4
    v_lshlrev_b32 v56, 5, v56
    v_lshl_add_u32 v56, v7, 3, v56
    s_lshl_b32 s52, s85, 9
    s_add_u32 s52, s52, s60
    s_add_u32 s52, s52, 134144
    v_add_u32 v56, s52, v56
    v_xor_b32 v57, 512, v56
    s_lshl_b32 s52, s20, 13
    s_add_u32 s52, s52, 65536
    v_lshlrev_b32 v3, 1, v8
    v_bfe_u32 v5, v1, 1, 2
    v_xor_b32 v6, v3, v5
    v_lshlrev_b32 v6, 4, v6
    v_lshl_add_u32 v6, v9, 6, v6
    v_add_u32 v60, s52, v6
    v_xor_b32 v61, 16, v60
    v_lshl_add_u32 v6, v8, 2, v4
    v_lshrrev_b32 v2, 1, v6
    v_xor_b32 v2, v2, v7
    v_lshlrev_b32 v2, 4, v2
    v_lshl_add_u32 v2, v6, 6, v2
    v_and_b32 v3, 1, v1
    v_lshl_add_u32 v2, v3, 3, v2
    v_add_u32 v62, s52, v2
    v_add_u32 v241, s52, v26
    v_lshl_add_u32 v242, v1, 2, s52
    v_and_b32 v245, 15, v1
    v_lshlrev_b32 v249, 7, v245
    v_mul_u32_u24 v245, 4, v245
    v_mov_b32 v252, 0x3f803f80
    v_mov_b32 v253, 0x3f803f80
    v_mov_b32 v254, 0x3f803f80
    v_mov_b32 v255, 0x3f803f80
    s_lshl_b32 s52, s50, 2
    s_add_u32 s52, s52, s20
    s_lshl_b32 s90, s52, 15
    s_add_u32 s90, s90, 4194304
    s_and_b32 s52, s52, 0xfffe
    s_mul_i32 s87, s52, 64
    s_add_u32 s87, s87, 8392704
    s_lshl_b32 s88, s52, 5
    s_add_u32 s88, s88, s48
    s_lshl_b32 s88, s88, 10
    s_add_u32 s88, s88, 4194304
    s_lshl_b32 s53, s62, 10
    s_add_u32 s21, s88, s53
    s_add_u32 s22, s21, 32768
    s_lshl_b32 s53, s85, 10
    s_add_u32 s88, s88, s53
    s_add_u32 s89, s88, 32768
    s_mov_b32 s85, 0
    s_mul_i32 s33, s51, 0
    s_mul_i32 s34, s51, 0
    s_and_b32 s35, s50, 3
    s_mul_i32 s35, s35, 0
    s_lshr_b32 s32, s48, 1
    s_mul_i32 s32, s32, 4
    v_lshl_add_u32 v2, v8, 5, s46
    s_lshl_b32 s53, s51, 8
    s_add_u32 s53, s53, 2048
    v_lshl_add_u32 v3, v9, 2, s53
    v_lshl_add_u32 v247, v2, 12, v3
    s_lshl_b32 s91, s51, 7
    s_lshl_b32 s52, s20, 13
    s_add_u32 s91, s91, s52
    s_lshl_b32 s33, s51, 16
    s_add_u32 s33, s33, s91
    s_lshl_b32 s44, s20, 10
    s_add_u32 s44, s44, 0
    s_and_b32 s52, s50, 3
    s_lshl_b32 s52, s52, 7
    s_lshl_b32 s53, s20, 5
    s_add_u32 s52, s52, s53
    v_add_u32 v251, s52, v9
    v_mov_b32 v36, 0x3f80
    v_mov_b32 v37, 0x3f800000
    v_lshlrev_b32 v2, 3, v8
    v_sub_u32 v2, v9, v2
    v_cmp_eq_u32 vcc, 0, v2
    s_nop 1
    v_cndmask_b32 v3, 0, v36, vcc
    v_cmp_eq_u32 vcc, 1, v2
    s_nop 1
    v_cndmask_b32 v4, v3, v37, vcc
    v_cmp_eq_u32 vcc, 2, v2
    s_nop 1
    v_cndmask_b32 v3, 0, v36, vcc
    v_cmp_eq_u32 vcc, 3, v2
    s_nop 1
    v_cndmask_b32 v5, v3, v37, vcc
    v_cmp_eq_u32 vcc, 4, v2
    s_nop 1
    v_cndmask_b32 v3, 0, v36, vcc
    v_cmp_eq_u32 vcc, 5, v2
    s_nop 1
    v_cndmask_b32 v6, v3, v37, vcc
    v_cmp_eq_u32 vcc, 6, v2
    s_nop 1
    v_cndmask_b32 v3, 0, v36, vcc
    v_cmp_eq_u32 vcc, 7, v2
    s_nop 1
    v_cndmask_b32 v7, v3, v37, vcc
    v_and_b32 v2, 48, v1
    v_cmp_eq_u32 vcc, 16, v2
    s_nop 1
    v_cndmask_b32 v0, 0, v36, vcc
    s_waitcnt lgkmcnt(0)
    s_add_u32 s52, s36, 9502848
    s_addc_u32 s53, s37, 0
    s_load_dword s3, s[52:53], 0
    buffer_store_dwordx4 v[52:55], v26, s[64:67], s54 offen sc1
    buffer_store_dword v52, v250, s[64:67], s86 offen sc1
    s_add_u32 m0, s60, 134144
    s_nop 0
    buffer_load_dwordx4 v26, s[96:99], s84 offen lds
    buffer_load_dword v27, v245, s[36:39], s87 offen sc1
    s_add_u32 m0, s60, 35840
    s_nop 0
    buffer_load_dwordx4 v13, s[24:27], s5 offen lds
    s_add_u32 m0, s61, 49152
    s_nop 0
    buffer_load_dwordx4 v14, s[28:31], s13 offen lds
    s_add_u32 m0, s61, 50176
    s_nop 0
    buffer_load_dwordx4 v15, s[28:31], s13 offen lds
    s_add_u32 m0, s61, 57344
    s_nop 0
    buffer_load_dwordx4 v16, s[28:31], s13 offen lds
    s_add_u32 m0, s61, 58368
    s_nop 0
    buffer_load_dwordx4 v17, s[28:31], s13 offen lds
    s_waitcnt lgkmcnt(0)
    s_add_u32 s3, s3, 1
    s_max_u32 s3, s3, 1
    v_mov_b32 v246, s3
    s_getreg_b32 s23, hwreg(HW_REG_XCC_ID)
    s_and_b32 s23, s23, 7
    s_lshl_b32 s52, s3, 3
    s_or_b32 s23, s23, s52
    s_lshl_b32 s47, s50, 10
    s_add_u32 s47, s47, 9453568
    s_lshl_b32 s52, s51, 7
    s_cmp_eq_u32 s20, 0
    s_cselect_b32 s52, s52, 0x7ff00000
    v_mov_b32 v58, s52
    v_mov_b32_e64 v59, s23
    s_waitcnt vmcnt(12) lgkmcnt(0)
    s_barrier
    ds_read_b128 a[0:3], v20
    ds_read_b64_tr_b16 v[128:129], v24 offset:0
    ds_read_b64_tr_b16 v[130:131], v24 offset:512
    ds_read_b128 a[4:7], v20 offset:4096
    ds_read_b64_tr_b16 v[132:133], v24 offset:8192
    ds_read_b64_tr_b16 v[134:135], v24 offset:8704
    ds_read_b128 a[8:11], v21
    ds_read_b64_tr_b16 v[136:137], v24 offset:2048
    ds_read_b64_tr_b16 v[138:139], v24 offset:2560
    ds_read_b128 a[12:15], v21 offset:4096
    ds_read_b64_tr_b16 v[140:141], v24 offset:10240
    ds_read_b64_tr_b16 v[142:143], v24 offset:10752
    s_add_u32 m0, s60, 65536
    s_nop 0
    buffer_load_dwordx4 v10, s[24:27], s6 offen lds
    s_add_u32 m0, s60, 66560
    s_nop 0
    buffer_load_dwordx4 v11, s[24:27], s6 offen lds
    s_add_u32 m0, s60, 67584
    s_nop 0
    buffer_load_dwordx4 v12, s[24:27], s6 offen lds
    s_add_u32 m0, s60, 68608
    s_nop 0
    buffer_load_dwordx4 v13, s[24:27], s6 offen lds
    s_add_u32 m0, s61, 81920
    s_nop 0
    buffer_load_dwordx4 v14, s[28:31], s14 offen lds
    s_add_u32 m0, s61, 82944
    s_nop 0
    buffer_load_dwordx4 v15, s[28:31], s14 offen lds
    s_add_u32 m0, s61, 90112
    s_nop 0
    buffer_load_dwordx4 v16, s[28:31], s14 offen lds
    s_add_u32 m0, s61, 91136
    s_nop 0
    buffer_load_dwordx4 v17, s[28:31], s14 offen lds
    s_waitcnt lgkmcnt(6)
    v_mfma_f32_32x32x16_bf16 v[64:79], v[128:131], a[0:3], 0
    ds_read_b128 a[16:19], v22
    ds_read_b64_tr_b16 v[144:145], v24 offset:4096
    v_mfma_f32_32x32x16_bf16 v[80:95], v[128:131], a[4:7], 0
    ds_read_b64_tr_b16 v[146:147], v24 offset:4608
    ds_read_b128 a[20:23], v22 offset:4096
    s_add_u32 m0, s60, 98304
    s_nop 0
    buffer_load_dwordx4 v10, s[24:27], s7 offen lds
    v_mfma_f32_32x32x16_bf16 v[96:111], a[0:3], v[132:135], 0
    ds_read_b64_tr_b16 v[148:149], v24 offset:12288
    ds_read_b64_tr_b16 v[150:151], v24 offset:12800
    v_mfma_f32_32x32x16_bf16 v[112:127], a[4:7], v[132:135], 0
    s_add_u32 m0, s60, 99328
    s_nop 0
    buffer_load_dwordx4 v11, s[24:27], s7 offen lds
    s_waitcnt lgkmcnt(6)
    v_mfma_f32_32x32x16_bf16 v[64:79], v[136:139], a[8:11], v[64:79]
    ds_read_b128 a[24:27], v23
    ds_read_b64_tr_b16 v[128:129], v24 offset:6144
    v_mfma_f32_32x32x16_bf16 v[80:95], v[136:139], a[12:15], v[80:95]
    ds_read_b64_tr_b16 v[130:131], v24 offset:6656
    ds_read_b128 a[28:31], v23 offset:4096
    s_add_u32 m0, s60, 100352
    s_nop 0
    buffer_load_dwordx4 v12, s[24:27], s7 offen lds
    v_mfma_f32_32x32x16_bf16 v[96:111], a[8:11], v[140:143], v[96:111]
    ds_read_b64_tr_b16 v[132:133], v24 offset:14336
    ds_read_b64_tr_b16 v[134:135], v24 offset:14848
    v_mfma_f32_32x32x16_bf16 v[112:127], a[12:15], v[140:143], v[112:127]
    s_add_u32 m0, s60, 101376
    s_nop 0
    buffer_load_dwordx4 v13, s[24:27], s7 offen lds
    s_waitcnt lgkmcnt(6)
    v_mfma_f32_32x32x16_bf16 v[64:79], v[144:147], a[16:19], v[64:79]
    s_waitcnt vmcnt(12)
    s_barrier
    ds_read_b64_tr_b16 v[28:29], v56 offset:0
    ds_read_b64_tr_b16 v[30:31], v56 offset:256
    ds_read_b64_tr_b16 v[32:33], v57 offset:0
    ds_read_b64_tr_b16 v[34:35], v57 offset:256
    v_add_u32 v20, 32768, v20
    v_add_u32 v24, 32768, v24
    s_add_u32 m0, s61, 114688
    s_nop 0
    buffer_load_dwordx4 v14, s[28:31], s15 offen lds
    v_bfe_u32 v2, v1, 2, 1
    v_mul_u32_u24 v2, 0x8000, v2
    v_mfma_f32_32x32x16_bf16 v[80:95], v[144:147], a[20:23], v[80:95]
    ds_read_b128 a[32:35], v20
    ds_read_b64_tr_b16 v[136:137], v24 offset:0
    v_lshl_or_b32 v2, v2, 16, v2
    v_mfma_f32_32x32x16_bf16 v[96:111], a[16:19], v[148:151], v[96:111]
    ds_read_b64_tr_b16 v[138:139], v24 offset:512
    ds_read_b128 a[36:39], v20 offset:4096
    s_add_u32 m0, s61, 115712
    s_nop 0
    buffer_load_dwordx4 v15, s[28:31], s15 offen lds
    v_mfma_f32_32x32x16_bf16 v[112:127], a[20:23], v[148:151], v[112:127]
    ds_read_b64_tr_b16 v[140:141], v24 offset:8192
    ds_read_b64_tr_b16 v[142:143], v24 offset:8704
    s_waitcnt lgkmcnt(10)
    v_mfma_f32_32x32x16_bf16 v[64:79], v[128:131], a[24:27], v[64:79]
    v_add_u32 v21, 32768, v21
    ds_read_b128 a[40:43], v21
    s_add_u32 m0, s61, 122880
    s_nop 0
    buffer_load_dwordx4 v16, s[28:31], s15 offen lds
    v_mfma_f32_32x32x16_bf16 v[80:95], v[128:131], a[28:31], v[80:95]
    ds_read_b64_tr_b16 v[144:145], v24 offset:2048
    ds_read_b64_tr_b16 v[146:147], v24 offset:2560
    v_mfma_f32_32x32x16_bf16 v[96:111], a[24:27], v[132:135], v[96:111]
    ds_read_b128 a[44:47], v21 offset:4096
    ds_read_b64_tr_b16 v[148:149], v24 offset:10240
    s_add_u32 m0, s61, 123904
    s_nop 0
    buffer_load_dwordx4 v17, s[28:31], s15 offen lds
    s_waitcnt lgkmcnt(11)
    v_xor_b32 v28, v2, v28
    v_mfma_f32_32x32x16_bf16 v[112:127], a[28:31], v[132:135], v[112:127]
    ds_read_b64_tr_b16 v[150:151], v24 offset:10752
    s_add_u32 m0, s60, 131072
    s_nop 0
    buffer_load_dwordx4 v10, s[24:27], s8 offen lds
    v_xor_b32_e64 v29, v2, v29
    v_xor_b32 v30, v2, v30
    v_xor_b32 v31, v2, v31
    s_waitcnt lgkmcnt(6)
    v_mfma_f32_32x32x16_bf16 v[64:79], v[136:139], a[32:35], v[64:79]
    v_add_u32 v22, 32768, v22
    ds_read_b128 a[48:51], v22
    v_xor_b32 v32, v2, v32
    v_xor_b32 v33, v2, v33
    v_mfma_f32_32x32x16_bf16 v[80:95], v[136:139], a[36:39], v[80:95]
    ds_read_b64_tr_b16 v[128:129], v24 offset:4096
    ds_read_b64_tr_b16 v[130:131], v24 offset:4608
    s_add_u32 m0, s60, 132096
    s_nop 0
    buffer_load_dwordx4 v11, s[24:27], s8 offen lds
    v_xor_b32 v34, v2, v34
    v_xor_b32 v35, v2, v35
    v_mfma_f32_32x32x16_bf16 v[96:111], a[32:35], v[140:143], v[96:111]
    ds_read_b128 a[52:55], v22 offset:4096
    ds_read_b64_tr_b16 v[132:133], v24 offset:12288
    v_mfma_f32_32x32x16_bf16 v[112:127], a[36:39], v[140:143], v[112:127]
    ds_read_b64_tr_b16 v[134:135], v24 offset:12800
    s_add_u32 m0, s60, 133120
    s_nop 0
    buffer_load_dwordx4 v12, s[24:27], s8 offen lds
    s_waitcnt lgkmcnt(6)
    v_mfma_f32_32x32x16_bf16 v[64:79], v[144:147], a[40:43], v[64:79]
    v_add_u32 v23, 32768, v23
    ds_read_b128 a[56:59], v23
    v_mfma_f32_32x32x16_bf16 v[80:95], v[144:147], a[44:47], v[80:95]
    ds_read_b64_tr_b16 v[136:137], v24 offset:6144
    ds_read_b64_tr_b16 v[138:139], v24 offset:6656
    s_add_u32 m0, s60, 134144
    s_nop 0
    buffer_load_dwordx4 v13, s[24:27], s8 offen lds
    v_mfma_f32_32x32x16_bf16 v[96:111], a[40:43], v[148:151], v[96:111]
    ds_read_b128 a[60:63], v23 offset:4096
    ds_read_b64_tr_b16 v[140:141], v24 offset:14336
    v_mfma_f32_32x32x16_bf16 v[112:127], a[44:47], v[148:151], v[112:127]
    ds_read_b64_tr_b16 v[142:143], v24 offset:14848
    s_add_u32 m0, s61, 147456
    s_nop 0
    buffer_load_dwordx4 v14, s[28:31], s16 offen lds
    s_waitcnt lgkmcnt(6)
    v_mfma_f32_32x32x16_bf16 v[64:79], v[128:131], a[48:51], v[64:79]
    s_waitcnt vmcnt(13)
    s_barrier
    v_add_u32 v20, 32768, v20
    v_add_u32 v24, 32768, v24
    s_add_u32 m0, s61, 148480
    s_nop 0
    buffer_load_dwordx4 v15, s[28:31], s16 offen lds
    v_mfma_f32_32x32x16_bf16 v[80:95], v[128:131], a[52:55], v[80:95]
    ds_read_b128 a[64:67], v20
    ds_read_b64_tr_b16 v[144:145], v24 offset:0
    v_mfma_f32_32x32x16_bf16 v[96:111], a[48:51], v[132:135], v[96:111]
    ds_read_b64_tr_b16 v[146:147], v24 offset:512
    ds_read_b128 a[68:71], v20 offset:4096
    s_add_u32 m0, s61, 155648
    s_nop 0
    buffer_load_dwordx4 v16, s[28:31], s16 offen lds
    v_mfma_f32_32x32x16_bf16 v[112:127], a[52:55], v[132:135], v[112:127]
    ds_read_b64_tr_b16 v[148:149], v24 offset:8192
    ds_read_b64_tr_b16 v[150:151], v24 offset:8704
    s_waitcnt lgkmcnt(6)
    v_mfma_f32_32x32x16_bf16 v[64:79], v[136:139], a[56:59], v[64:79]
    v_add_u32 v21, 32768, v21
    ds_read_b128 a[72:75], v21
    s_add_u32 m0, s61, 156672
    s_nop 0
    buffer_load_dwordx4 v17, s[28:31], s16 offen lds
    v_mfma_f32_32x32x16_bf16 v[80:95], v[136:139], a[60:63], v[80:95]
    ds_read_b64_tr_b16 v[128:129], v24 offset:2048
    ds_read_b64_tr_b16 v[130:131], v24 offset:2560
    v_mfma_f32_32x32x16_bf16 v[96:111], a[56:59], v[140:143], v[96:111]
    ds_read_b128 a[76:79], v21 offset:4096
    ds_read_b64_tr_b16 v[132:133], v24 offset:10240
    s_add_u32 m0, s60, 0
    s_nop 0
    buffer_load_dwordx4 v10, s[24:27], s9 offen lds
    v_mfma_f32_32x32x16_bf16 v[112:127], a[60:63], v[140:143], v[112:127]
    ds_read_b64_tr_b16 v[134:135], v24 offset:10752
    s_add_u32 m0, s60, 1024
    s_nop 0
    buffer_load_dwordx4 v11, s[24:27], s9 offen lds
    s_waitcnt lgkmcnt(6)
    v_mfma_f32_32x32x16_bf16 v[64:79], v[144:147], a[64:67], v[64:79]
    v_add_u32 v22, 32768, v22
    ds_read_b128 a[80:83], v22
    v_mfma_f32_32x32x16_bf16 v[80:95], v[144:147], a[68:71], v[80:95]
    ds_read_b64_tr_b16 v[136:137], v24 offset:4096
    ds_read_b64_tr_b16 v[138:139], v24 offset:4608
    s_add_u32 m0, s60, 2048
    s_nop 0
    buffer_load_dwordx4 v12, s[24:27], s9 offen lds
    v_mfma_f32_32x32x16_bf16 v[96:111], a[64:67], v[148:151], v[96:111]
    ds_read_b128 a[84:87], v22 offset:4096
    ds_read_b64_tr_b16 v[140:141], v24 offset:12288
    v_mfma_f32_32x32x16_bf16 v[112:127], a[68:71], v[148:151], v[112:127]
    ds_read_b64_tr_b16 v[142:143], v24 offset:12800
    s_add_u32 m0, s60, 3072
    s_nop 0
    buffer_load_dwordx4 v13, s[24:27], s9 offen lds
    s_waitcnt lgkmcnt(6)
    v_mfma_f32_32x32x16_bf16 v[64:79], v[128:131], a[72:75], v[64:79]
    v_add_u32 v23, 32768, v23
    ds_read_b128 a[88:91], v23
    v_mfma_f32_32x32x16_bf16 v[80:95], v[128:131], a[76:79], v[80:95]
    ds_read_b64_tr_b16 v[144:145], v24 offset:6144
    ds_read_b64_tr_b16 v[146:147], v24 offset:6656
    s_add_u32 m0, s61, 16384
    s_nop 0
    buffer_load_dwordx4 v14, s[28:31], s17 offen lds
    v_mfma_f32_32x32x16_bf16 v[96:111], a[72:75], v[132:135], v[96:111]
    ds_read_b128 a[92:95], v23 offset:4096
    ds_read_b64_tr_b16 v[148:149], v24 offset:14336
    v_mfma_f32_32x32x16_bf16 v[112:127], a[76:79], v[132:135], v[112:127]
    ds_read_b64_tr_b16 v[150:151], v24 offset:14848
    s_add_u32 m0, s61, 17408
    s_nop 0
    buffer_load_dwordx4 v15, s[28:31], s17 offen lds
    s_waitcnt lgkmcnt(6)
    v_mfma_f32_32x32x16_bf16 v[64:79], v[136:139], a[80:83], v[64:79]
    s_waitcnt vmcnt(14)
    s_barrier
    v_add_u32 v20, 32768, v20
    v_add_u32 v24, 32768, v24
    s_add_u32 m0, s61, 24576
    s_nop 0
    buffer_load_dwordx4 v16, s[28:31], s17 offen lds
    v_mfma_f32_32x32x16_bf16 v[80:95], v[136:139], a[84:87], v[80:95]
    ds_read_b128 a[96:99], v20
    ds_read_b64_tr_b16 v[128:129], v24 offset:0
    v_mfma_f32_32x32x16_bf16 v[96:111], a[80:83], v[140:143], v[96:111]
    ds_read_b64_tr_b16 v[130:131], v24 offset:512
    ds_read_b128 a[100:103], v20 offset:4096
    s_add_u32 m0, s61, 25600
    s_nop 0
    buffer_load_dwordx4 v17, s[28:31], s17 offen lds
    v_mfma_f32_32x32x16_bf16 v[112:127], a[84:87], v[140:143], v[112:127]
    ds_read_b64_tr_b16 v[132:133], v24 offset:8192
    ds_read_b64_tr_b16 v[134:135], v24 offset:8704
    s_waitcnt lgkmcnt(6)
    v_mfma_f32_32x32x16_bf16 v[64:79], v[144:147], a[88:91], v[64:79]
    v_add_u32 v21, 32768, v21
    ds_read_b128 a[104:107], v21
    s_add_u32 m0, s60, 32768
    s_nop 0
    buffer_load_dwordx4 v10, s[24:27], s10 offen lds
    v_mfma_f32_32x32x16_bf16 v[80:95], v[144:147], a[92:95], v[80:95]
    ds_read_b64_tr_b16 v[136:137], v24 offset:2048
    ds_read_b64_tr_b16 v[138:139], v24 offset:2560
    v_mfma_f32_32x32x16_bf16 v[96:111], a[88:91], v[148:151], v[96:111]
    ds_read_b128 a[108:111], v21 offset:4096
    ds_read_b64_tr_b16 v[140:141], v24 offset:10240
    s_add_u32 m0, s60, 33792
    s_nop 0
    buffer_load_dwordx4 v11, s[24:27], s10 offen lds
    v_mfma_f32_32x32x16_bf16 v[112:127], a[92:95], v[148:151], v[112:127]
    ds_read_b64_tr_b16 v[142:143], v24 offset:10752
    s_add_u32 m0, s60, 34816
    s_nop 0
    buffer_load_dwordx4 v12, s[24:27], s10 offen lds
    s_waitcnt lgkmcnt(6)
    v_mfma_f32_32x32x16_bf16 v[64:79], v[128:131], a[96:99], v[64:79]
    v_add_u32 v22, 32768, v22
    ds_read_b128 a[112:115], v22
    v_mfma_f32_32x32x16_bf16 v[80:95], v[128:131], a[100:103], v[80:95]
    ds_read_b64_tr_b16 v[144:145], v24 offset:4096
    ds_read_b64_tr_b16 v[146:147], v24 offset:4608
    s_add_u32 m0, s60, 35840
    s_nop 0
    buffer_load_dwordx4 v13, s[24:27], s10 offen lds
    v_mfma_f32_32x32x16_bf16 v[96:111], a[96:99], v[132:135], v[96:111]
    ds_read_b128 a[116:119], v22 offset:4096
    ds_read_b64_tr_b16 v[148:149], v24 offset:12288
    v_mfma_f32_32x32x16_bf16 v[112:127], a[100:103], v[132:135], v[112:127]
    ds_read_b64_tr_b16 v[150:151], v24 offset:12800
    s_add_u32 m0, s61, 49152
    s_nop 0
    buffer_load_dwordx4 v14, s[28:31], s18 offen lds
    s_waitcnt lgkmcnt(6)
    v_mfma_f32_32x32x16_bf16 v[64:79], v[136:139], a[104:107], v[64:79]
    v_add_u32 v23, 32768, v23
    ds_read_b128 a[120:123], v23
    v_mfma_f32_32x32x16_bf16 v[80:95], v[136:139], a[108:111], v[80:95]
    ds_read_b64_tr_b16 v[128:129], v24 offset:6144
    ds_read_b64_tr_b16 v[130:131], v24 offset:6656
    s_add_u32 m0, s61, 50176
    s_nop 0
    buffer_load_dwordx4 v15, s[28:31], s18 offen lds
    v_mfma_f32_32x32x16_bf16 v[96:111], a[104:107], v[140:143], v[96:111]
    ds_read_b128 a[124:127], v23 offset:4096
    ds_read_b64_tr_b16 v[132:133], v24 offset:14336
    v_mfma_f32_32x32x16_bf16 v[112:127], a[108:111], v[140:143], v[112:127]
    ds_read_b64_tr_b16 v[134:135], v24 offset:14848
    s_add_u32 m0, s61, 57344
    s_nop 0
    buffer_load_dwordx4 v16, s[28:31], s18 offen lds
    s_waitcnt lgkmcnt(6)
    v_mfma_f32_32x32x16_bf16 v[64:79], v[144:147], a[112:115], v[64:79]
    s_waitcnt vmcnt(15)
    s_barrier
    v_add_u32 v20, 32768, v20
    v_add_u32 v24, 32768, v24
    s_add_u32 m0, s61, 58368
    s_nop 0
    buffer_load_dwordx4 v17, s[28:31], s18 offen lds
    v_mfma_f32_32x32x16_bf16 v[80:95], v[144:147], a[116:119], v[80:95]
    ds_read_b128 a[128:131], v20
    ds_read_b64_tr_b16 v[136:137], v24 offset:0
    v_mfma_f32_32x32x16_bf16 v[96:111], a[112:115], v[148:151], v[96:111]
    ds_read_b64_tr_b16 v[138:139], v24 offset:512
    ds_read_b128 a[132:135], v20 offset:4096
    s_add_u32 m0, s60, 65536
    s_nop 0
    buffer_load_dwordx4 v10, s[24:27], s11 offen lds
    v_mfma_f32_32x32x16_bf16 v[112:127], a[116:119], v[148:151], v[112:127]
    ds_read_b64_tr_b16 v[140:141], v24 offset:8192
    ds_read_b64_tr_b16 v[142:143], v24 offset:8704
    s_waitcnt lgkmcnt(6)
    v_mfma_f32_32x32x16_bf16 v[64:79], v[128:131], a[120:123], v[64:79]
    v_add_u32 v21, 32768, v21
    ds_read_b128 a[136:139], v21
    s_add_u32 m0, s60, 66560
    s_nop 0
    buffer_load_dwordx4 v11, s[24:27], s11 offen lds
    v_mfma_f32_32x32x16_bf16 v[80:95], v[128:131], a[124:127], v[80:95]
    ds_read_b64_tr_b16 v[144:145], v24 offset:2048
    ds_read_b64_tr_b16 v[146:147], v24 offset:2560
    v_mfma_f32_32x32x16_bf16 v[96:111], a[120:123], v[132:135], v[96:111]
    ds_read_b128 a[140:143], v21 offset:4096
    ds_read_b64_tr_b16 v[148:149], v24 offset:10240
    s_add_u32 m0, s60, 67584
    s_nop 0
    buffer_load_dwordx4 v12, s[24:27], s11 offen lds
    v_mfma_f32_32x32x16_bf16 v[112:127], a[124:127], v[132:135], v[112:127]
    ds_read_b64_tr_b16 v[150:151], v24 offset:10752
    s_add_u32 m0, s60, 68608
    s_nop 0
    buffer_load_dwordx4 v13, s[24:27], s11 offen lds
    s_waitcnt lgkmcnt(6)
    v_mfma_f32_32x32x16_bf16 v[64:79], v[136:139], a[128:131], v[64:79]
    v_add_u32 v22, 32768, v22
    ds_read_b128 a[144:147], v22
    v_mfma_f32_32x32x16_bf16 v[80:95], v[136:139], a[132:135], v[80:95]
    ds_read_b64_tr_b16 v[128:129], v24 offset:4096
    ds_read_b64_tr_b16 v[130:131], v24 offset:4608
    s_add_u32 m0, s61, 81920
    s_nop 0
    buffer_load_dwordx4 v14, s[28:31], s19 offen lds
    v_mfma_f32_32x32x16_bf16 v[96:111], a[128:131], v[140:143], v[96:111]
    ds_read_b128 a[148:151], v22 offset:4096
    ds_read_b64_tr_b16 v[132:133], v24 offset:12288
    v_mfma_f32_32x32x16_bf16 v[112:127], a[132:135], v[140:143], v[112:127]
    ds_read_b64_tr_b16 v[134:135], v24 offset:12800
    s_add_u32 m0, s61, 82944
    s_nop 0
    buffer_load_dwordx4 v15, s[28:31], s19 offen lds
    s_waitcnt lgkmcnt(6)
    v_mfma_f32_32x32x16_bf16 v[64:79], v[144:147], a[136:139], v[64:79]
    v_add_u32 v23, 32768, v23
    ds_read_b128 a[152:155], v23
    v_mfma_f32_32x32x16_bf16 v[80:95], v[144:147], a[140:143], v[80:95]
    ds_read_b64_tr_b16 v[136:137], v24 offset:6144
    ds_read_b64_tr_b16 v[138:139], v24 offset:6656
    s_add_u32 m0, s61, 90112
    s_nop 0
    buffer_load_dwordx4 v16, s[28:31], s19 offen lds
    v_mfma_f32_32x32x16_bf16 v[96:111], a[136:139], v[148:151], v[96:111]
    ds_read_b128 a[156:159], v23 offset:4096
    ds_read_b64_tr_b16 v[140:141], v24 offset:14336
    v_mfma_f32_32x32x16_bf16 v[112:127], a[140:143], v[148:151], v[112:127]
    ds_read_b64_tr_b16 v[142:143], v24 offset:14848
    s_add_u32 m0, s61, 91136
    s_nop 0
    buffer_load_dwordx4 v17, s[28:31], s19 offen lds
    s_waitcnt lgkmcnt(6)
    v_mfma_f32_32x32x16_bf16 v[64:79], v[128:131], a[144:147], v[64:79]
    s_waitcnt vmcnt(16)
    s_barrier
    v_subrev_u32 v20, 131072, v20
    v_subrev_u32 v24, 131072, v24
    v_mfma_f32_32x32x16_bf16 v[80:95], v[128:131], a[148:151], v[80:95]
    ds_read_b128 a[160:163], v20
    ds_read_b64_tr_b16 v[144:145], v24 offset:0
    s_mov_b32 exec_hi, 0
    v_lshlrev_b32 v3, 10, v251
    v_mul_u32_u24 v2, 3072, v251
    s_lshl_b32 s52, s51, 7
    buffer_load_dword v27, v2, s[28:31], s52 offen
    buffer_load_dword v27, v3, s[92:95], s52 offen
    s_mov_b64 exec, -1
    v_mfma_f32_32x32x16_bf16 v[96:111], a[144:147], v[132:135], v[96:111]
    ds_read_b64_tr_b16 v[146:147], v24 offset:512
    ds_read_b128 a[164:167], v20 offset:4096
    s_lshl_b32 s52, s50, 7
    s_add_u32 s52, s52, 18432
    v_mov_b32_e64 v2, s52
    s_mov_b64 exec, 1
    buffer_store_dword v246, v2, s[64:67], 0 offen sc1
    s_mov_b64 exec, -1
    v_mfma_f32_32x32x16_bf16 v[112:127], a[148:151], v[132:135], v[112:127]
    ds_read_b64_tr_b16 v[148:149], v24 offset:8192
    ds_read_b64_tr_b16 v[150:151], v24 offset:8704
    s_mov_b64 exec, 1
    buffer_store_dword v59, v58, s[36:39], s47 offen sc1
    s_mov_b64 exec, -1
    s_waitcnt lgkmcnt(6)
    v_mfma_f32_32x32x16_bf16 v[64:79], v[136:139], a[152:155], v[64:79]
    v_subrev_u32 v21, 131072, v21
    ds_read_b128 a[168:171], v21
    v_mfma_f32_32x32x16_bf16 v[80:95], v[136:139], a[156:159], v[80:95]
    ds_read_b64_tr_b16 v[128:129], v24 offset:2048
    ds_read_b64_tr_b16 v[130:131], v24 offset:2560
    v_mfma_f32_32x32x16_bf16 v[96:111], a[152:155], v[140:143], v[96:111]
    ds_read_b128 a[172:175], v21 offset:4096
    ds_read_b64_tr_b16 v[132:133], v24 offset:10240
    v_mfma_f32_32x32x16_bf16 v[112:127], a[156:159], v[140:143], v[112:127]
    ds_read_b64_tr_b16 v[134:135], v24 offset:10752
    s_waitcnt lgkmcnt(6)
    v_mfma_f32_32x32x16_bf16 v[64:79], v[144:147], a[160:163], v[64:79]
    v_subrev_u32 v22, 131072, v22
    ds_read_b128 a[176:179], v22
    v_mfma_f32_32x32x16_bf16 v[80:95], v[144:147], a[164:167], v[80:95]
    ds_read_b64_tr_b16 v[136:137], v24 offset:4096
    ds_read_b64_tr_b16 v[138:139], v24 offset:4608
    v_mfma_f32_32x32x16_bf16 v[96:111], a[160:163], v[148:151], v[96:111]
    ds_read_b128 a[180:183], v22 offset:4096
    ds_read_b64_tr_b16 v[140:141], v24 offset:12288
    v_mfma_f32_32x32x16_bf16 v[112:127], a[164:167], v[148:151], v[112:127]
    ds_read_b64_tr_b16 v[142:143], v24 offset:12800
    s_waitcnt lgkmcnt(6)
    v_mfma_f32_32x32x16_bf16 v[64:79], v[128:131], a[168:171], v[64:79]
    v_subrev_u32 v23, 131072, v23
    ds_read_b128 a[184:187], v23
    v_mfma_f32_32x32x16_bf16 v[80:95], v[128:131], a[172:175], v[80:95]
    ds_read_b64_tr_b16 v[144:145], v24 offset:6144
    ds_read_b64_tr_b16 v[146:147], v24 offset:6656
    v_mfma_f32_32x32x16_bf16 v[96:111], a[168:171], v[132:135], v[96:111]
    ds_read_b128 a[188:191], v23 offset:4096
    ds_read_b64_tr_b16 v[148:149], v24 offset:14336
    v_mfma_f32_32x32x16_bf16 v[112:127], a[172:175], v[132:135], v[112:127]
    ds_read_b64_tr_b16 v[150:151], v24 offset:14848
    s_waitcnt lgkmcnt(6)
    v_mfma_f32_32x32x16_bf16 v[64:79], v[136:139], a[176:179], v[64:79]
    s_waitcnt vmcnt(12)
    s_barrier
    v_add_u32 v20, 32768, v20
    v_add_u32 v24, 32768, v24
    v_mfma_f32_32x32x16_bf16 v[80:95], v[136:139], a[180:183], v[80:95]
    ds_read_b128 a[192:195], v20
    ds_read_b64_tr_b16 v[128:129], v24 offset:0
    v_mfma_f32_32x32x16_bf16 v[96:111], a[176:179], v[140:143], v[96:111]
    ds_read_b64_tr_b16 v[130:131], v24 offset:512
    ds_read_b128 a[196:199], v20 offset:4096
    v_mfma_f32_32x32x16_bf16 v[112:127], a[180:183], v[140:143], v[112:127]
    ds_read_b64_tr_b16 v[132:133], v24 offset:8192
    ds_read_b64_tr_b16 v[134:135], v24 offset:8704
    s_waitcnt lgkmcnt(6)
    v_mfma_f32_32x32x16_bf16 v[64:79], v[144:147], a[184:187], v[64:79]
    v_add_u32 v21, 32768, v21
    ds_read_b128 a[200:203], v21
    v_mfma_f32_32x32x16_bf16 v[80:95], v[144:147], a[188:191], v[80:95]
    ds_read_b64_tr_b16 v[136:137], v24 offset:2048
    ds_read_b64_tr_b16 v[138:139], v24 offset:2560
    v_mfma_f32_32x32x16_bf16 v[96:111], a[184:187], v[148:151], v[96:111]
    ds_read_b128 a[204:207], v21 offset:4096
    ds_read_b64_tr_b16 v[140:141], v24 offset:10240
    v_mfma_f32_32x32x16_bf16 v[112:127], a[188:191], v[148:151], v[112:127]
    ds_read_b64_tr_b16 v[142:143], v24 offset:10752
    s_waitcnt lgkmcnt(6)
    v_mfma_f32_32x32x16_bf16 v[64:79], v[128:131], a[192:195], v[64:79]
    v_add_u32 v22, 32768, v22
    ds_read_b128 a[208:211], v22
    v_mfma_f32_32x32x16_bf16 v[80:95], v[128:131], a[196:199], v[80:95]
    ds_read_b64_tr_b16 v[144:145], v24 offset:4096
    ds_read_b64_tr_b16 v[146:147], v24 offset:4608
    v_mfma_f32_32x32x16_bf16 v[96:111], a[192:195], v[132:135], v[96:111]
    ds_read_b128 a[212:215], v22 offset:4096
    ds_read_b64_tr_b16 v[148:149], v24 offset:12288
    v_mfma_f32_32x32x16_bf16 v[112:127], a[196:199], v[132:135], v[112:127]
    ds_read_b64_tr_b16 v[150:151], v24 offset:12800
    s_waitcnt lgkmcnt(6)
    v_mfma_f32_32x32x16_bf16 v[64:79], v[136:139], a[200:203], v[64:79]
    v_add_u32 v23, 32768, v23
    ds_read_b128 a[216:219], v23
    v_mfma_f32_32x32x16_bf16 v[80:95], v[136:139], a[204:207], v[80:95]
    ds_read_b64_tr_b16 v[128:129], v24 offset:6144
    ds_read_b64_tr_b16 v[130:131], v24 offset:6656
    v_mfma_f32_32x32x16_bf16 v[96:111], a[200:203], v[140:143], v[96:111]
    ds_read_b128 a[220:223], v23 offset:4096
    ds_read_b64_tr_b16 v[132:133], v24 offset:14336
    v_mfma_f32_32x32x16_bf16 v[112:127], a[204:207], v[140:143], v[112:127]
    ds_read_b64_tr_b16 v[134:135], v24 offset:14848
    s_waitcnt lgkmcnt(6)
    v_mfma_f32_32x32x16_bf16 v[64:79], v[144:147], a[208:211], v[64:79]
    s_waitcnt vmcnt(4)
    s_barrier
    v_add_u32 v20, 32768, v20
    v_add_u32 v24, 32768, v24
    v_mfma_f32_32x32x16_bf16 v[80:95], v[144:147], a[212:215], v[80:95]
    ds_read_b128 a[224:227], v20
    ds_read_b64_tr_b16 v[136:137], v24 offset:0
    v_mfma_f32_32x32x16_bf16 v[96:111], a[208:211], v[148:151], v[96:111]
    ds_read_b64_tr_b16 v[138:139], v24 offset:512
    ds_read_b128 a[228:231], v20 offset:4096
    v_mfma_f32_32x32x16_bf16 v[112:127], a[212:215], v[148:151], v[112:127]
    ds_read_b64_tr_b16 v[140:141], v24 offset:8192
    ds_read_b64_tr_b16 v[142:143], v24 offset:8704
    s_waitcnt lgkmcnt(6)
    v_mfma_f32_32x32x16_bf16 v[64:79], v[128:131], a[216:219], v[64:79]
    v_add_u32 v21, 32768, v21
    ds_read_b128 a[232:235], v21
    v_mfma_f32_32x32x16_bf16 v[80:95], v[128:131], a[220:223], v[80:95]
    ds_read_b64_tr_b16 v[144:145], v24 offset:2048
    ds_read_b64_tr_b16 v[146:147], v24 offset:2560
    v_mfma_f32_32x32x16_bf16 v[96:111], a[216:219], v[132:135], v[96:111]
    ds_read_b128 a[236:239], v21 offset:4096
    ds_read_b64_tr_b16 v[148:149], v24 offset:10240
    s_add_u32 m0, s61, 98304
    s_nop 0
    buffer_load_dwordx4 v18, s[28:31], s12 offen lds
    v_mfma_f32_32x32x16_bf16 v[112:127], a[220:223], v[132:135], v[112:127]
    ds_read_b64_tr_b16 v[150:151], v24 offset:10752
    s_waitcnt lgkmcnt(6)
    v_mfma_f32_32x32x16_bf16 v[64:79], v[136:139], a[224:227], v[64:79]
    v_add_u32 v22, 32768, v22
    ds_read_b128 a[240:243], v22
    s_add_u32 m0, s61, 99328
    s_nop 0
    buffer_load_dwordx4 v19, s[28:31], s12 offen lds
    v_mfma_f32_32x32x16_bf16 v[80:95], v[136:139], a[228:231], v[80:95]
    ds_read_b64_tr_b16 v[128:129], v24 offset:4096
    ds_read_b64_tr_b16 v[130:131], v24 offset:4608
    v_mfma_f32_32x32x16_bf16 v[96:111], a[224:227], v[140:143], v[96:111]
    ds_read_b128 a[244:247], v22 offset:4096
    ds_read_b64_tr_b16 v[132:133], v24 offset:12288
    s_add_u32 m0, s61, 106496
    s_nop 0
    buffer_load_dwordx4 v18, s[28:31], s13 offen lds
    v_mfma_f32_32x32x16_bf16 v[112:127], a[228:231], v[140:143], v[112:127]
    ds_read_b64_tr_b16 v[134:135], v24 offset:12800
    s_waitcnt lgkmcnt(6)
    v_mfma_f32_32x32x16_bf16 v[64:79], v[144:147], a[232:235], v[64:79]
    v_add_u32 v23, 32768, v23
    ds_read_b128 a[248:251], v23
    s_add_u32 m0, s61, 107520
    s_nop 0
    buffer_load_dwordx4 v19, s[28:31], s13 offen lds
    v_mfma_f32_32x32x16_bf16 v[80:95], v[144:147], a[236:239], v[80:95]
    ds_read_b64_tr_b16 v[136:137], v24 offset:6144
    ds_read_b64_tr_b16 v[138:139], v24 offset:6656
    v_mfma_f32_32x32x16_bf16 v[96:111], a[232:235], v[148:151], v[96:111]
    ds_read_b128 a[252:255], v23 offset:4096
    ds_read_b64_tr_b16 v[140:141], v24 offset:14336
    s_add_u32 m0, s61, 114688
    s_nop 0
    buffer_load_dwordx4 v18, s[28:31], s14 offen lds
    v_mfma_f32_32x32x16_bf16 v[112:127], a[236:239], v[148:151], v[112:127]
    ds_read_b64_tr_b16 v[142:143], v24 offset:14848
    s_waitcnt lgkmcnt(6)
    v_mfma_f32_32x32x16_bf16 v[64:79], v[128:131], a[240:243], v[64:79]
    s_add_u32 m0, s61, 115712
    s_nop 0
    buffer_load_dwordx4 v19, s[28:31], s14 offen lds
    v_mfma_f32_32x32x16_bf16 v[80:95], v[128:131], a[244:247], v[80:95]
    v_mfma_f32_32x32x16_bf16 v[96:111], a[240:243], v[132:135], v[96:111]
    s_add_u32 m0, s61, 122880
    s_nop 0
    buffer_load_dwordx4 v18, s[28:31], s15 offen lds
    v_mfma_f32_32x32x16_bf16 v[112:127], a[244:247], v[132:135], v[112:127]
    s_waitcnt lgkmcnt(0)
    s_barrier
    v_mfma_f32_32x32x16_bf16 v[64:79], v[136:139], a[248:251], v[64:79]
    s_add_u32 m0, s61, 123904
    s_nop 0
    buffer_load_dwordx4 v19, s[28:31], s15 offen lds
    v_mfma_f32_32x32x16_bf16 v[80:95], v[136:139], a[252:255], v[80:95]
    v_mfma_f32_32x32x16_bf16 v[96:111], a[248:251], v[140:143], v[96:111]
    v_mfma_f32_32x32x16_bf16 v[112:127], a[252:255], v[140:143], v[112:127]
    s_nop 5
    v_cvt_pk_bf16_f32 v36, v64, v65
    v_cvt_pk_bf16_f32 v37, v66, v67
    v_cvt_pk_bf16_f32 v38, v68, v69
    v_cvt_pk_bf16_f32 v39, v70, v71
    v_cvt_pk_bf16_f32 v40, v80, v81
    v_cvt_pk_bf16_f32 v41, v82, v83
    v_cvt_pk_bf16_f32 v42, v84, v85
    v_cvt_pk_bf16_f32 v43, v86, v87
    v_mfma_f32_32x32x16_bf16 v[128:143], v[28:31], v[36:39], 0
    s_nop 0
    v_mfma_f32_32x32x16_bf16 v[144:159], v[28:31], v[40:43], 0
    v_cvt_pk_bf16_f32 v44, v72, v73
    v_cvt_pk_bf16_f32 v45, v74, v75
    v_cvt_pk_bf16_f32 v46, v76, v77
    v_cvt_pk_bf16_f32 v47, v78, v79
    v_cvt_pk_bf16_f32 v48, v88, v89
    v_cvt_pk_bf16_f32 v49, v90, v91
    v_cvt_pk_bf16_f32 v50, v92, v93
    v_cvt_pk_bf16_f32 v51, v94, v95
    v_mfma_f32_32x32x16_bf16 v[160:175], v[32:35], v[44:47], 0
    s_nop 0
    v_mfma_f32_32x32x16_bf16 v[176:191], v[32:35], v[48:51], 0
    v_cvt_pk_bf16_f32 v96, v96, v97
    v_cvt_pk_bf16_f32 v97, v98, v99
    v_cvt_pk_bf16_f32 v98, v100, v101
    v_cvt_pk_bf16_f32 v99, v102, v103
    v_cvt_pk_bf16_f32 v100, v104, v105
    v_cvt_pk_bf16_f32 v101, v106, v107
    v_cvt_pk_bf16_f32 v102, v108, v109
    v_cvt_pk_bf16_f32 v103, v110, v111
    v_cvt_pk_bf16_f32 v104, v112, v113
    v_cvt_pk_bf16_f32 v105, v114, v115
    v_cvt_pk_bf16_f32 v106, v116, v117
    v_cvt_pk_bf16_f32 v107, v118, v119
    v_cvt_pk_bf16_f32 v108, v120, v121
    v_cvt_pk_bf16_f32 v109, v122, v123
    v_cvt_pk_bf16_f32 v110, v124, v125
    v_cvt_pk_bf16_f32 v111, v126, v127
    v_xor_b32 v2, 16384, v241
    v_xor_b32 v9, 16384, v242
    v_add_u32 v24, 98304, v240
    v_max3_f32 v52, v128, v129, v130
    v_max3_f32 v56, v144, v145, v146
    v_max3_f32 v53, v131, v132, v133
    v_max3_f32 v57, v147, v148, v149
    v_max3_f32 v52, v52, v134, v135
    v_max3_f32 v56, v56, v150, v151
    v_max3_f32 v53, v53, v136, v137
    v_max3_f32 v57, v57, v152, v153
    v_max3_f32 v52, v52, v138, v139
    v_max3_f32 v56, v56, v154, v155
    v_max3_f32 v53, v53, v140, v141
    v_max3_f32 v57, v57, v156, v157
    v_max3_f32 v52, v52, v142, v143
    v_max3_f32 v56, v56, v158, v159
    v_max_f32 v52, v52, v53
    v_max_f32 v56, v56, v57
    v_mul_f32 v52, s69, v52
    v_mul_f32 v56, s69, v56
    v_pk_fma_f32 v[128:129], v[128:129], s[68:69], v[52:53] op_sel:[0,0,0] op_sel_hi:[1,0,0]
    v_pk_fma_f32 v[144:145], v[144:145], s[68:69], v[56:57] op_sel:[0,0,0] op_sel_hi:[1,0,0]
    v_pk_fma_f32 v[130:131], v[130:131], s[68:69], v[52:53] op_sel:[0,0,0] op_sel_hi:[1,0,0]
    v_pk_fma_f32 v[146:147], v[146:147], s[68:69], v[56:57] op_sel:[0,0,0] op_sel_hi:[1,0,0]
    v_pk_fma_f32 v[132:133], v[132:133], s[68:69], v[52:53] op_sel:[0,0,0] op_sel_hi:[1,0,0]
    v_pk_fma_f32 v[148:149], v[148:149], s[68:69], v[56:57] op_sel:[0,0,0] op_sel_hi:[1,0,0]
    v_pk_fma_f32 v[134:135], v[134:135], s[68:69], v[52:53] op_sel:[0,0,0] op_sel_hi:[1,0,0]
    v_pk_fma_f32 v[150:151], v[150:151], s[68:69], v[56:57] op_sel:[0,0,0] op_sel_hi:[1,0,0]
    v_pk_fma_f32 v[136:137], v[136:137], s[68:69], v[52:53] op_sel:[0,0,0] op_sel_hi:[1,0,0]
    v_pk_fma_f32 v[152:153], v[152:153], s[68:69], v[56:57] op_sel:[0,0,0] op_sel_hi:[1,0,0]
    v_pk_fma_f32 v[138:139], v[138:139], s[68:69], v[52:53] op_sel:[0,0,0] op_sel_hi:[1,0,0]
    v_pk_fma_f32 v[154:155], v[154:155], s[68:69], v[56:57] op_sel:[0,0,0] op_sel_hi:[1,0,0]
    v_pk_fma_f32 v[140:141], v[140:141], s[68:69], v[52:53] op_sel:[0,0,0] op_sel_hi:[1,0,0]
    v_pk_fma_f32 v[156:157], v[156:157], s[68:69], v[56:57] op_sel:[0,0,0] op_sel_hi:[1,0,0]
    v_pk_fma_f32 v[142:143], v[142:143], s[68:69], v[52:53] op_sel:[0,0,0] op_sel_hi:[1,0,0]
    v_pk_fma_f32 v[158:159], v[158:159], s[68:69], v[56:57] op_sel:[0,0,0] op_sel_hi:[1,0,0]
    v_exp_f32 v128, v128
    v_exp_f32 v144, v144
    v_exp_f32 v129, v129
    v_exp_f32 v145, v145
    v_exp_f32 v130, v130
    v_exp_f32 v146, v146
    s_add_u32 m0, s61, 131072
    s_nop 0
    buffer_load_dwordx4 v18, s[28:31], s16 offen lds
    v_exp_f32 v131, v131
    v_exp_f32 v147, v147
    v_exp_f32 v132, v132
    v_exp_f32 v148, v148
    v_exp_f32 v133, v133
    v_exp_f32 v149, v149
    v_exp_f32 v134, v134
    v_exp_f32 v150, v150
    v_exp_f32 v135, v135
    v_exp_f32 v151, v151
    v_exp_f32 v136, v136
    v_exp_f32 v152, v152
    v_exp_f32 v137, v137
    v_exp_f32 v153, v153
    v_exp_f32 v138, v138
    v_exp_f32 v154, v154
    v_exp_f32 v139, v139
    v_exp_f32 v155, v155
    v_exp_f32 v140, v140
    v_exp_f32 v156, v156
    v_exp_f32 v141, v141
    v_exp_f32 v157, v157
    v_exp_f32 v142, v142
    v_exp_f32 v158, v158
    v_exp_f32 v143, v143
    v_exp_f32 v159, v159
    v_pk_add_f32 v[52:53], v[128:129], v[130:131]
    v_pk_add_f32 v[56:57], v[144:145], v[146:147]
    v_pk_add_f32 v[54:55], v[132:133], v[134:135]
    v_pk_add_f32 v[58:59], v[148:149], v[150:151]
    s_add_u32 m0, s61, 132096
    s_nop 0
    buffer_load_dwordx4 v19, s[28:31], s16 offen lds
    v_pk_add_f32 v[52:53], v[52:53], v[136:137]
    v_pk_add_f32 v[56:57], v[56:57], v[152:153]
    v_pk_add_f32 v[54:55], v[54:55], v[138:139]
    v_pk_add_f32 v[58:59], v[58:59], v[154:155]
    v_pk_add_f32 v[52:53], v[52:53], v[140:141]
    v_pk_add_f32 v[56:57], v[56:57], v[156:157]
    v_pk_add_f32 v[54:55], v[54:55], v[142:143]
    v_pk_add_f32 v[58:59], v[58:59], v[158:159]
    v_pk_add_f32 v[52:53], v[52:53], v[54:55]
    v_pk_add_f32 v[56:57], v[56:57], v[58:59]
    v_add_f32 v52, v52, v53
    v_add_f32 v56, v56, v57
    v_rcp_f32 v52, v52
    v_rcp_f32 v56, v56
    v_pk_mul_f32 v[128:129], v[128:129], v[52:53] op_sel:[0,0] op_sel_hi:[1,0]
    v_pk_mul_f32 v[144:145], v[144:145], v[56:57] op_sel:[0,0] op_sel_hi:[1,0]
    v_pk_mul_f32 v[130:131], v[130:131], v[52:53] op_sel:[0,0] op_sel_hi:[1,0]
    v_pk_mul_f32 v[146:147], v[146:147], v[56:57] op_sel:[0,0] op_sel_hi:[1,0]
    v_pk_mul_f32 v[132:133], v[132:133], v[52:53] op_sel:[0,0] op_sel_hi:[1,0]
    v_pk_mul_f32 v[148:149], v[148:149], v[56:57] op_sel:[0,0] op_sel_hi:[1,0]
    v_pk_mul_f32 v[134:135], v[134:135], v[52:53] op_sel:[0,0] op_sel_hi:[1,0]
    v_pk_mul_f32 v[150:151], v[150:151], v[56:57] op_sel:[0,0] op_sel_hi:[1,0]
    v_pk_mul_f32 v[136:137], v[136:137], v[52:53] op_sel:[0,0] op_sel_hi:[1,0]
    v_pk_mul_f32 v[152:153], v[152:153], v[56:57] op_sel:[0,0] op_sel_hi:[1,0]
    v_pk_mul_f32 v[138:139], v[138:139], v[52:53] op_sel:[0,0] op_sel_hi:[1,0]
    v_pk_mul_f32 v[154:155], v[154:155], v[56:57] op_sel:[0,0] op_sel_hi:[1,0]
    v_pk_mul_f32 v[140:141], v[140:141], v[52:53] op_sel:[0,0] op_sel_hi:[1,0]
    v_pk_mul_f32 v[156:157], v[156:157], v[56:57] op_sel:[0,0] op_sel_hi:[1,0]
    v_pk_mul_f32 v[142:143], v[142:143], v[52:53] op_sel:[0,0] op_sel_hi:[1,0]
    v_pk_mul_f32 v[158:159], v[158:159], v[56:57] op_sel:[0,0] op_sel_hi:[1,0]
    s_mov_b32 s52, 18432
    buffer_load_dword v251, v249, s[64:67], s52 offen sc1
    v_cvt_pk_bf16_f32 v192, v128, v129
    v_cvt_pk_bf16_f32 v200, v144, v145
    v_cvt_pk_bf16_f32 v193, v130, v131
    v_cvt_pk_bf16_f32 v201, v146, v147
    v_cvt_pk_bf16_f32 v194, v132, v133
    v_cvt_pk_bf16_f32 v202, v148, v149
    v_cvt_pk_bf16_f32 v195, v134, v135
    ds_write_b128 v60, v[192:195] offset:0
    v_cvt_pk_bf16_f32 v203, v150, v151
    ds_write_b128 v60, v[200:203] offset:2048
    v_cvt_pk_bf16_f32 v196, v136, v137
    v_cvt_pk_bf16_f32 v204, v152, v153
    v_cvt_pk_bf16_f32 v197, v138, v139
    v_cvt_pk_bf16_f32 v205, v154, v155
    v_cvt_pk_bf16_f32 v198, v140, v141
    v_cvt_pk_bf16_f32 v206, v156, v157
    v_cvt_pk_bf16_f32 v199, v142, v143
    ds_write_b128 v61, v[196:199] offset:0
    v_cvt_pk_bf16_f32 v207, v158, v159
    ds_write_b128 v61, v[204:207] offset:2048
    ds_read_b64_tr_b16 v[64:65], v62 offset:0
    ds_read_b64_tr_b16 v[66:67], v62 offset:512
    ds_read_b64_tr_b16 v[68:69], v62 offset:1024
    ds_read_b64_tr_b16 v[70:71], v62 offset:1536
    ds_read_b64_tr_b16 v[72:73], v62 offset:2048
    ds_read_b64_tr_b16 v[74:75], v62 offset:2560
    ds_read_b64_tr_b16 v[76:77], v62 offset:3072
    ds_read_b64_tr_b16 v[78:79], v62 offset:3584
    v_max3_f32 v52, v160, v161, v162
    v_max3_f32 v56, v176, v177, v178
    v_max3_f32 v53, v163, v164, v165
    v_max3_f32 v57, v179, v180, v181
    v_max3_f32 v52, v52, v166, v167
    v_max3_f32 v56, v56, v182, v183
    v_max3_f32 v53, v53, v168, v169
    v_max3_f32 v57, v57, v184, v185
    v_max3_f32 v52, v52, v170, v171
    v_max3_f32 v56, v56, v186, v187
    v_max3_f32 v53, v53, v172, v173
    v_max3_f32 v57, v57, v188, v189
    v_max3_f32 v52, v52, v174, v175
    v_max3_f32 v56, v56, v190, v191
    v_and_b32 v3, 7, v1
    v_lshlrev_b32 v3, 7, v3
    buffer_load_dword v248, v3, s[36:39], s47 offen sc1
    v_max_f32 v52, v52, v53
    v_max_f32 v56, v56, v57
    v_mul_f32 v52, s69, v52
    v_mul_f32 v56, s69, v56
    v_pk_fma_f32 v[160:161], v[160:161], s[68:69], v[52:53] op_sel:[0,0,0] op_sel_hi:[1,0,0]
    v_pk_fma_f32 v[176:177], v[176:177], s[68:69], v[56:57] op_sel:[0,0,0] op_sel_hi:[1,0,0]
    v_pk_fma_f32 v[162:163], v[162:163], s[68:69], v[52:53] op_sel:[0,0,0] op_sel_hi:[1,0,0]
    v_pk_fma_f32 v[178:179], v[178:179], s[68:69], v[56:57] op_sel:[0,0,0] op_sel_hi:[1,0,0]
    v_pk_fma_f32 v[164:165], v[164:165], s[68:69], v[52:53] op_sel:[0,0,0] op_sel_hi:[1,0,0]
    v_pk_fma_f32 v[180:181], v[180:181], s[68:69], v[56:57] op_sel:[0,0,0] op_sel_hi:[1,0,0]
    v_pk_fma_f32 v[166:167], v[166:167], s[68:69], v[52:53] op_sel:[0,0,0] op_sel_hi:[1,0,0]
    v_pk_fma_f32 v[182:183], v[182:183], s[68:69], v[56:57] op_sel:[0,0,0] op_sel_hi:[1,0,0]
    v_pk_fma_f32 v[168:169], v[168:169], s[68:69], v[52:53] op_sel:[0,0,0] op_sel_hi:[1,0,0]
    v_pk_fma_f32 v[184:185], v[184:185], s[68:69], v[56:57] op_sel:[0,0,0] op_sel_hi:[1,0,0]
    v_pk_fma_f32 v[170:171], v[170:171], s[68:69], v[52:53] op_sel:[0,0,0] op_sel_hi:[1,0,0]
    v_pk_fma_f32 v[186:187], v[186:187], s[68:69], v[56:57] op_sel:[0,0,0] op_sel_hi:[1,0,0]
    v_pk_fma_f32 v[172:173], v[172:173], s[68:69], v[52:53] op_sel:[0,0,0] op_sel_hi:[1,0,0]
    v_pk_fma_f32 v[188:189], v[188:189], s[68:69], v[56:57] op_sel:[0,0,0] op_sel_hi:[1,0,0]
    v_pk_fma_f32 v[174:175], v[174:175], s[68:69], v[52:53] op_sel:[0,0,0] op_sel_hi:[1,0,0]
    v_pk_fma_f32 v[190:191], v[190:191], s[68:69], v[56:57] op_sel:[0,0,0] op_sel_hi:[1,0,0]
    s_waitcnt lgkmcnt(6)
    v_mfma_f32_32x32x16_bf16 v[112:127], v[96:99], v[64:67], 0
    v_exp_f32 v160, v160
    v_exp_f32 v176, v176
    v_exp_f32 v161, v161
    v_exp_f32 v177, v177
    s_waitcnt lgkmcnt(4)
    v_mfma_f32_32x32x16_bf16 v[112:127], v[100:103], v[68:71], v[112:127]
    v_exp_f32 v162, v162
    v_exp_f32 v178, v178
    v_exp_f32 v163, v163
    v_exp_f32 v179, v179
    s_waitcnt lgkmcnt(2)
    v_mfma_f32_32x32x16_bf16 v[112:127], v[104:107], v[72:75], v[112:127]
    v_exp_f32 v164, v164
    v_exp_f32 v180, v180
    v_exp_f32 v165, v165
    v_exp_f32 v181, v181
    s_waitcnt lgkmcnt(0)
    v_mfma_f32_32x32x16_bf16 v[112:127], v[108:111], v[76:79], v[112:127]
    v_exp_f32 v166, v166
    v_exp_f32 v182, v182
    v_exp_f32 v167, v167
    v_exp_f32 v183, v183
    v_mfma_f32_32x32x16_bf16 v[128:143], v[252:255], v[64:67], 0
    v_exp_f32 v168, v168
    v_exp_f32 v184, v184
    v_exp_f32 v169, v169
    v_exp_f32 v185, v185
    v_mfma_f32_32x32x16_bf16 v[128:143], v[252:255], v[68:71], v[128:143]
    v_exp_f32 v170, v170
    v_exp_f32 v186, v186
    v_exp_f32 v171, v171
    v_exp_f32 v187, v187
    v_mfma_f32_32x32x16_bf16 v[128:143], v[252:255], v[72:75], v[128:143]
    v_exp_f32 v172, v172
    v_exp_f32 v188, v188
    v_exp_f32 v173, v173
    v_exp_f32 v189, v189
    v_mfma_f32_32x32x16_bf16 v[128:143], v[252:255], v[76:79], v[128:143]
    v_exp_f32 v174, v174
    v_exp_f32 v190, v190
    v_exp_f32 v175, v175
    v_exp_f32 v191, v191
    v_pk_add_f32 v[52:53], v[160:161], v[162:163]
    v_pk_add_f32 v[56:57], v[176:177], v[178:179]
    v_pk_add_f32 v[54:55], v[164:165], v[166:167]
    v_pk_add_f32 v[58:59], v[180:181], v[182:183]
    v_pk_add_f32 v[52:53], v[52:53], v[168:169]
    v_pk_add_f32 v[56:57], v[56:57], v[184:185]
    v_pk_add_f32 v[54:55], v[54:55], v[170:171]
    v_pk_add_f32 v[58:59], v[58:59], v[186:187]
    v_pk_add_f32 v[52:53], v[52:53], v[172:173]
    v_pk_add_f32 v[56:57], v[56:57], v[188:189]
    v_pk_add_f32 v[54:55], v[54:55], v[174:175]
    v_pk_add_f32 v[58:59], v[58:59], v[190:191]
    v_pk_add_f32 v[52:53], v[52:53], v[54:55]
    v_pk_add_f32 v[56:57], v[56:57], v[58:59]
    v_add_f32 v52, v52, v53
    v_add_f32 v56, v56, v57
    v_rcp_f32 v52, v52
    v_rcp_f32 v56, v56
    v_pk_mul_f32 v[160:161], v[160:161], v[52:53] op_sel:[0,0] op_sel_hi:[1,0]
    v_pk_mul_f32 v[176:177], v[176:177], v[56:57] op_sel:[0,0] op_sel_hi:[1,0]
    ds_write_b128 v241, v[112:115]
    v_pk_mul_f32 v[162:163], v[162:163], v[52:53] op_sel:[0,0] op_sel_hi:[1,0]
    v_pk_mul_f32 v[178:179], v[178:179], v[56:57] op_sel:[0,0] op_sel_hi:[1,0]
    v_pk_mul_f32 v[164:165], v[164:165], v[52:53] op_sel:[0,0] op_sel_hi:[1,0]
    v_pk_mul_f32 v[180:181], v[180:181], v[56:57] op_sel:[0,0] op_sel_hi:[1,0]
    v_pk_mul_f32 v[166:167], v[166:167], v[52:53] op_sel:[0,0] op_sel_hi:[1,0]
    ds_write_b128 v241, v[116:119] offset:1024
    v_pk_mul_f32 v[182:183], v[182:183], v[56:57] op_sel:[0,0] op_sel_hi:[1,0]
    v_pk_mul_f32 v[168:169], v[168:169], v[52:53] op_sel:[0,0] op_sel_hi:[1,0]
    v_pk_mul_f32 v[184:185], v[184:185], v[56:57] op_sel:[0,0] op_sel_hi:[1,0]
    v_pk_mul_f32 v[170:171], v[170:171], v[52:53] op_sel:[0,0] op_sel_hi:[1,0]
    v_pk_mul_f32 v[186:187], v[186:187], v[56:57] op_sel:[0,0] op_sel_hi:[1,0]
    ds_write_b32 v242, v128 offset:2048
    v_pk_mul_f32 v[172:173], v[172:173], v[52:53] op_sel:[0,0] op_sel_hi:[1,0]
    v_pk_mul_f32 v[188:189], v[188:189], v[56:57] op_sel:[0,0] op_sel_hi:[1,0]
    v_pk_mul_f32 v[174:175], v[174:175], v[52:53] op_sel:[0,0] op_sel_hi:[1,0]
    v_pk_mul_f32 v[190:191], v[190:191], v[56:57] op_sel:[0,0] op_sel_hi:[1,0]
    v_cvt_pk_bf16_f32 v208, v160, v161
    v_cvt_pk_bf16_f32 v216, v176, v177
    v_cvt_pk_bf16_f32 v209, v162, v163
    v_cvt_pk_bf16_f32 v217, v178, v179
    v_cvt_pk_bf16_f32 v210, v164, v165
    v_cvt_pk_bf16_f32 v218, v180, v181
    s_waitcnt vmcnt(2) lgkmcnt(0)
    s_barrier
    ds_read_b128 v[152:155], v2
    ds_read_b128 v[156:159], v2 offset:1024
    ds_read_b32 v128, v9 offset:2048
    v_cvt_pk_bf16_f32 v211, v166, v167
    ds_write_b128 v60, v[208:211] offset:4096
    v_cvt_pk_bf16_f32 v219, v182, v183
    ds_write_b128 v60, v[216:219] offset:6144
    v_cvt_pk_bf16_f32 v212, v168, v169
    v_cvt_pk_bf16_f32 v220, v184, v185
    v_cvt_pk_bf16_f32 v213, v170, v171
    v_cvt_pk_bf16_f32 v221, v186, v187
    v_cvt_pk_bf16_f32 v214, v172, v173
    v_cvt_pk_bf16_f32 v222, v188, v189
    v_cvt_pk_bf16_f32 v215, v174, v175
    ds_write_b128 v61, v[212:215] offset:4096
    v_cvt_pk_bf16_f32 v223, v190, v191
    ds_write_b128 v61, v[220:223] offset:6144
    ds_read_b64_tr_b16 v[80:81], v62 offset:4096
    ds_read_b64_tr_b16 v[82:83], v62 offset:4608
    ds_read_b64_tr_b16 v[84:85], v62 offset:5120
    ds_read_b64_tr_b16 v[86:87], v62 offset:5632
    ds_read_b64_tr_b16 v[88:89], v62 offset:6144
    ds_read_b64_tr_b16 v[90:91], v62 offset:6656
    ds_read_b64_tr_b16 v[92:93], v62 offset:7168
    ds_read_b64_tr_b16 v[94:95], v62 offset:7680
    ds_read_b64_tr_b16 v[224:225], v24 offset:0
    ds_read_b64_tr_b16 v[226:227], v24 offset:512
    ds_read_b64_tr_b16 v[228:229], v24 offset:2048
    ds_read_b64_tr_b16 v[230:231], v24 offset:2560
    ds_read_b64_tr_b16 v[232:233], v24 offset:4096
    ds_read_b64_tr_b16 v[234:235], v24 offset:4608
    ds_read_b64_tr_b16 v[236:237], v24 offset:6144
    ds_read_b64_tr_b16 v[238:239], v24 offset:6656
    s_waitcnt lgkmcnt(14)
    v_mfma_f32_32x32x16_bf16 v[144:159], v[96:99], v[80:83], v[144:159]
    s_waitcnt lgkmcnt(12)
    s_add_u32 m0, s61, 139264
    s_nop 0
    buffer_load_dwordx4 v18, s[28:31], s17 offen lds
    v_mfma_f32_32x32x16_bf16 v[144:159], v[100:103], v[84:87], v[144:159]
    s_waitcnt lgkmcnt(10)
    v_mfma_f32_32x32x16_bf16 v[144:159], v[104:107], v[88:91], v[144:159]
    s_waitcnt lgkmcnt(8)
    s_add_u32 m0, s61, 140288
    s_nop 0
    buffer_load_dwordx4 v19, s[28:31], s17 offen lds
    v_mfma_f32_32x32x16_bf16 v[144:159], v[108:111], v[92:95], v[144:159]
    v_mfma_f32_32x32x16_bf16 v[128:143], v[252:255], v[80:83], v[128:143]
    s_add_u32 m0, s61, 147456
    s_nop 0
    buffer_load_dwordx4 v18, s[28:31], s18 offen lds
    v_mfma_f32_32x32x16_bf16 v[128:143], v[252:255], v[84:87], v[128:143]
    s_add_u32 m0, s61, 148480
    s_nop 0
    buffer_load_dwordx4 v19, s[28:31], s18 offen lds
    v_mfma_f32_32x32x16_bf16 v[128:143], v[252:255], v[88:91], v[128:143]
    v_mfma_f32_32x32x16_bf16 v[128:143], v[252:255], v[92:95], v[128:143]
    s_waitcnt lgkmcnt(6)
    s_add_u32 m0, s61, 155648
    s_nop 0
    buffer_load_dwordx4 v18, s[28:31], s19 offen lds
    v_mov_b32_e64 v252, v0
    v_mfma_f32_32x32x16_bf16 v[64:79], v[224:227], a[0:3], 0
    v_cvt_pk_bf16_f32 v40, v152, v153
    v_cvt_pk_bf16_f32 v41, v154, v155
    v_cvt_pk_bf16_f32 v42, v156, v157
    v_cvt_pk_bf16_f32 v43, v158, v159
    v_min_u32 v40, 0xfffffffe, v40
    v_min_u32 v41, 0xfffffffe, v41
    v_min_u32 v42, 0xfffffffe, v42
    v_min_u32 v43, 0xfffffffe, v43
    buffer_store_dwordx4 v[40:43], v26, s[64:67], s54 offen sc1
    v_min_u32 v3, 0xfffffffe, v128
    buffer_store_dword v3, v250, s[64:67], s86 offen sc1
    ds_read_b64_tr_b16 a[0:1], v24 offset:8192
    ds_read_b64_tr_b16 a[2:3], v24 offset:8704
    s_waitcnt lgkmcnt(6)
    v_mfma_f32_32x32x16_bf16 v[64:79], v[228:231], a[8:11], v[64:79]
    ds_read_b64_tr_b16 a[8:9], v24 offset:10240
    ds_read_b64_tr_b16 a[10:11], v24 offset:10752
    s_waitcnt lgkmcnt(6)
    v_mov_b32 v21, 0
    v_mov_b32 v22, 0
    s_add_u32 m0, s61, 156672
    s_nop 0
    buffer_load_dwordx4 v19, s[28:31], s19 offen lds
    v_mfma_f32_32x32x16_bf16 v[64:79], v[232:235], a[16:19], v[64:79]
    ds_read_b64_tr_b16 a[16:17], v24 offset:12288
    ds_read_b64_tr_b16 a[18:19], v24 offset:12800
    s_waitcnt lgkmcnt(6)
    s_waitcnt vmcnt(8)
    v_cmp_ne_u32 vcc, s23, v248
    s_nop 0
    s_or_b32 s23, vcc_lo, vcc_hi
    s_mov_b32 s52, 18432
    v_cmp_ne_u32 vcc, s3, v251
    s_cbranch_vccnz Lpfo_4
Lpfd_3:
    s_mov_b32 s53, 16384
    s_mov_b32 s4, s35
    s_xor_b32 s5, s35, 4096
    s_xor_b32 s6, s35, 8192
    s_xor_b32 s7, s35, 12288
    s_lshr_b32 s8, s4, 3
    s_lshr_b32 s9, s5, 3
    s_lshr_b32 s10, s6, 3
    s_lshr_b32 s11, s7, 3
    v_add_u32 v244, 16384, v244
    s_mov_b32 s59, 262144
    v_mfma_f32_32x32x16_bf16 v[64:79], v[236:239], a[24:27], v[64:79]
    ds_read_b64_tr_b16 a[24:25], v24 offset:14336
    ds_read_b64_tr_b16 a[26:27], v24 offset:14848
    s_waitcnt lgkmcnt(6)
    s_add_u32 m0, s44, 0
    s_mov_b32 s52, s33
    buffer_load_dwordx4 v25, s[92:95], s52 offen lds
    v_mfma_f32_32x32x16_bf16 v[64:79], a[0:3], a[32:35], v[64:79]
    ds_read_b64_tr_b16 a[32:33], v24 offset:16384
    ds_read_b64_tr_b16 a[34:35], v24 offset:16896
    s_waitcnt lgkmcnt(6)
    v_mov_b32 v23, 0
    s_lshl_b32 s58, s62, 10
    v_add_u32 v61, s58, v241
    v_mfma_f32_32x32x16_bf16 v[64:79], a[8:11], a[40:43], v[64:79]
    ds_read_b64_tr_b16 a[40:41], v24 offset:18432
    ds_read_b64_tr_b16 a[42:43], v24 offset:18944
    s_waitcnt lgkmcnt(6)
    s_add_u32 m0, s44, 4096
    s_add_u32 s52, s52, 32768
    buffer_load_dwordx4 v25, s[92:95], s52 offen lds
    v_mfma_f32_32x32x16_bf16 v[64:79], a[16:19], a[48:51], v[64:79]
    ds_read_b64_tr_b16 a[48:49], v24 offset:20480
    ds_read_b64_tr_b16 a[50:51], v24 offset:20992
    s_waitcnt lgkmcnt(6)
    v_xor_b32 v60, 1024, v61
    v_mfma_f32_32x32x16_bf16 v[64:79], a[24:27], a[56:59], v[64:79]
    ds_read_b64_tr_b16 a[56:57], v24 offset:22528
    ds_read_b64_tr_b16 a[58:59], v24 offset:23040
    s_waitcnt lgkmcnt(6)
    s_add_u32 m0, s44, 8192
    s_add_u32 s52, s91, 65536
    s_cmp_eq_u32 s51, 1
    s_cselect_b32 s52, s91, s52
    buffer_load_dwordx4 v25, s[92:95], s52 offen lds
    v_mfma_f32_32x32x16_bf16 v[64:79], a[32:35], a[64:67], v[64:79]
    ds_read_b64_tr_b16 a[64:65], v24 offset:24576
    ds_read_b64_tr_b16 a[66:67], v24 offset:25088
    s_waitcnt lgkmcnt(6)
    v_mfma_f32_32x32x16_bf16 v[64:79], a[40:43], a[72:75], v[64:79]
    ds_read_b64_tr_b16 a[72:73], v24 offset:26624
    ds_read_b64_tr_b16 a[74:75], v24 offset:27136
    s_waitcnt lgkmcnt(6)
    s_add_u32 m0, s44, 12288
    s_add_u32 s52, s52, 32768
    buffer_load_dwordx4 v25, s[92:95], s52 offen lds
    v_mfma_f32_32x32x16_bf16 v[64:79], a[48:51], a[80:83], v[64:79]
    ds_read_b64_tr_b16 a[80:81], v24 offset:28672
    ds_read_b64_tr_b16 a[82:83], v24 offset:29184
    s_waitcnt lgkmcnt(6)
    v_mfma_f32_32x32x16_bf16 v[64:79], a[56:59], a[88:91], v[64:79]
    ds_read_b64_tr_b16 a[88:89], v24 offset:30720
    ds_read_b64_tr_b16 a[90:91], v24 offset:31232
    s_waitcnt lgkmcnt(6)
    s_add_u32 m0, s44, 16384
    s_add_u32 s52, s91, 131072
    s_cmp_eq_u32 s51, 2
    s_cselect_b32 s52, s91, s52
    buffer_load_dwordx4 v25, s[92:95], s52 offen lds
    v_mfma_f32_32x32x16_bf16 v[64:79], a[64:67], a[96:99], v[64:79]
    ds_read_b64_tr_b16 a[96:97], v24 offset:32768
    ds_read_b64_tr_b16 a[98:99], v24 offset:33280
    s_waitcnt lgkmcnt(6)
    v_mfma_f32_32x32x16_bf16 v[64:79], a[72:75], a[104:107], v[64:79]
    ds_read_b64_tr_b16 a[104:105], v24 offset:34816
    ds_read_b64_tr_b16 a[106:107], v24 offset:35328
    s_waitcnt lgkmcnt(6)
    s_add_u32 m0, s44, 20480
    s_add_u32 s52, s52, 32768
    buffer_load_dwordx4 v25, s[92:95], s52 offen lds
    v_mfma_f32_32x32x16_bf16 v[64:79], a[80:83], a[112:115], v[64:79]
    ds_read_b64_tr_b16 a[112:113], v24 offset:36864
    ds_read_b64_tr_b16 a[114:115], v24 offset:37376
    s_waitcnt lgkmcnt(6)
    v_mfma_f32_32x32x16_bf16 v[64:79], a[88:91], a[120:123], v[64:79]
    ds_read_b64_tr_b16 a[120:121], v24 offset:38912
    ds_read_b64_tr_b16 a[122:123], v24 offset:39424
    s_waitcnt lgkmcnt(6)
    s_add_u32 m0, s44, 24576
    s_add_u32 s52, s91, 196608
    s_cmp_eq_u32 s51, 3
    s_cselect_b32 s52, s91, s52
    buffer_load_dwordx4 v25, s[92:95], s52 offen lds
    v_mfma_f32_32x32x16_bf16 v[64:79], a[96:99], a[128:131], v[64:79]
    s_waitcnt vmcnt(7)
    s_barrier
    ds_read_b64_tr_b16 a[128:129], v24 offset:40960
    ds_read_b64_tr_b16 a[130:131], v24 offset:41472
    s_waitcnt lgkmcnt(6)
    v_mfma_f32_32x32x16_bf16 v[64:79], a[104:107], a[136:139], v[64:79]
    ds_read_b64_tr_b16 a[136:137], v24 offset:43008
    ds_read_b64_tr_b16 a[138:139], v24 offset:43520
    s_waitcnt lgkmcnt(6)
    s_add_u32 m0, s44, 28672
    s_add_u32 s52, s52, 32768
    buffer_load_dwordx4 v25, s[92:95], s52 offen lds
    v_mfma_f32_32x32x16_bf16 v[64:79], a[112:115], a[144:147], v[64:79]
    ds_read_b64_tr_b16 a[144:145], v24 offset:45056
    ds_read_b64_tr_b16 a[146:147], v24 offset:45568
    s_waitcnt lgkmcnt(6)
    v_mfma_f32_32x32x16_bf16 v[64:79], a[120:123], a[152:155], v[64:79]
    ds_read_b64_tr_b16 a[152:153], v24 offset:47104
    ds_read_b64_tr_b16 a[154:155], v24 offset:47616
    s_add_u32 m0, s44, 32768
    s_add_u32 s52, s91, 262144
    s_cmp_eq_u32 s51, 4
    s_cselect_b32 s52, s91, s52
    buffer_load_dwordx4 v25, s[92:95], s52 offen lds
    s_waitcnt lgkmcnt(6)
    v_mfma_f32_32x32x16_bf16 v[64:79], a[128:131], a[160:163], v[64:79]
    ds_read_b64_tr_b16 a[160:161], v24 offset:49152
    ds_read_b64_tr_b16 a[162:163], v24 offset:49664
    s_waitcnt lgkmcnt(6)
    v_mfma_f32_32x32x16_bf16 v[64:79], a[136:139], a[168:171], v[64:79]
    ds_read_b64_tr_b16 a[168:169], v24 offset:51200
    ds_read_b64_tr_b16 a[170:171], v24 offset:51712
    s_waitcnt lgkmcnt(6)
    v_mfma_f32_32x32x16_bf16 v[64:79], a[144:147], a[176:179], v[64:79]
    ds_read_b64_tr_b16 a[176:177], v24 offset:53248
    ds_read_b64_tr_b16 a[178:179], v24 offset:53760
    s_waitcnt lgkmcnt(6)
    v_mfma_f32_32x32x16_bf16 v[64:79], a[152:155], a[184:187], v[64:79]
    ds_read_b64_tr_b16 a[184:185], v24 offset:55296
    ds_read_b64_tr_b16 a[186:187], v24 offset:55808
    buffer_load_dword v10, v244, s[64:67], s8 offen offset:0 sc1
    s_waitcnt lgkmcnt(6)
    v_mfma_f32_32x32x16_bf16 v[64:79], a[160:163], a[192:195], v[64:79]
    ds_read_b64_tr_b16 a[192:193], v24 offset:57344
    ds_read_b64_tr_b16 a[194:195], v24 offset:57856
    buffer_load_dword v11, v244, s[64:67], s8 offen offset:256 sc1
    s_waitcnt lgkmcnt(6)
    v_mfma_f32_32x32x16_bf16 v[64:79], a[168:171], a[200:203], v[64:79]
    ds_read_b64_tr_b16 a[200:201], v24 offset:59392
    ds_read_b64_tr_b16 a[202:203], v24 offset:59904
    buffer_load_dword v12, v244, s[64:67], s9 offen offset:0 sc1
    s_waitcnt lgkmcnt(6)
    v_mfma_f32_32x32x16_bf16 v[64:79], a[176:179], a[208:211], v[64:79]
    ds_read_b64_tr_b16 a[208:209], v24 offset:61440
    ds_read_b64_tr_b16 a[210:211], v24 offset:61952
    buffer_load_dword v13, v244, s[64:67], s9 offen offset:256 sc1
    s_waitcnt lgkmcnt(6)
    v_mfma_f32_32x32x16_bf16 v[64:79], a[184:187], a[216:219], v[64:79]
    ds_read_b64_tr_b16 a[216:217], v24 offset:63488
    ds_read_b64_tr_b16 a[218:219], v24 offset:64000
    buffer_load_dword v14, v244, s[64:67], s10 offen offset:0 sc1
    s_waitcnt lgkmcnt(6)
    v_mfma_f32_32x32x16_bf16 v[64:79], a[192:195], a[224:227], v[64:79]
    buffer_load_dword v15, v244, s[64:67], s10 offen offset:256 sc1
    s_waitcnt lgkmcnt(4)
    v_mfma_f32_32x32x16_bf16 v[64:79], a[200:203], a[232:235], v[64:79]
    buffer_load_dword v16, v244, s[64:67], s11 offen offset:0 sc1
    s_waitcnt lgkmcnt(2)
    v_mfma_f32_32x32x16_bf16 v[64:79], a[208:211], a[240:243], v[64:79]
    buffer_load_dword v17, v244, s[64:67], s11 offen offset:256 sc1
    s_waitcnt lgkmcnt(0)
    v_mfma_f32_32x32x16_bf16 v[64:79], a[216:219], a[248:251], v[64:79]
    s_nop 5
    v_mfma_f32_32x32x16_bf16 v[80:95], v[224:227], a[4:7], 0
    buffer_load_dwordx4 v[96:99], v243, s[64:67], s4 offen offset:0 sc1
    s_nop 2
    v_mfma_f32_32x32x16_bf16 v[80:95], v[228:231], a[12:15], v[80:95]
    v_cvt_pk_bf16_f32 v36, v64, v65
    v_cvt_pk_bf16_f32 v37, v66, v67
    v_cvt_pk_bf16_f32 v38, v68, v69
    v_cvt_pk_bf16_f32 v39, v70, v71
    v_cvt_pk_bf16_f32 v48, v72, v73
    v_mfma_f32_32x32x16_bf16 v[80:95], v[232:235], a[20:23], v[80:95]
    buffer_load_dwordx4 v[100:103], v243, s[64:67], s4 offen offset:1024 sc1
    v_cvt_pk_bf16_f32 v49, v74, v75
    v_cvt_pk_bf16_f32 v50, v76, v77
    v_cvt_pk_bf16_f32 v51, v78, v79
    v_mfma_f32_32x32x16_bf16 v[160:175], v[28:31], v[36:39], 0
    s_nop 0
    v_mfma_f32_32x32x16_bf16 v[176:191], v[32:35], v[48:51], 0
    buffer_load_dwordx4 v[104:107], v243, s[64:67], s4 offen offset:2048 sc1
    s_nop 2
    v_mfma_f32_32x32x16_bf16 v[80:95], v[236:239], a[28:31], v[80:95]
    s_nop 4
    v_max3_f32 v52, v160, v161, v162
    v_mfma_f32_32x32x16_bf16 v[80:95], a[0:3], a[36:39], v[80:95]
    buffer_load_dwordx4 v[108:111], v243, s[64:67], s4 offen offset:3072 sc1
    v_max3_f32 v56, v176, v177, v178
    v_max3_f32 v53, v163, v164, v165
    v_max3_f32 v57, v179, v180, v181
    v_mfma_f32_32x32x16_bf16 v[80:95], a[8:11], a[44:47], v[80:95]
    v_max3_f32 v52, v52, v166, v167
    v_max3_f32 v56, v56, v182, v183
    v_max3_f32 v53, v53, v168, v169
    v_max3_f32 v57, v57, v184, v185
    v_max3_f32 v52, v52, v170, v171
    v_mfma_f32_32x32x16_bf16 v[80:95], a[16:19], a[52:55], v[80:95]
    buffer_load_dwordx4 v[112:115], v243, s[64:67], s5 offen offset:0 sc1
    v_max3_f32 v56, v56, v186, v187
    v_max3_f32 v53, v53, v172, v173
    v_max3_f32 v57, v57, v188, v189
    v_mfma_f32_32x32x16_bf16 v[80:95], a[24:27], a[60:63], v[80:95]
    v_max3_f32 v52, v52, v174, v175
    v_max3_f32 v56, v56, v190, v191
    v_max_f32 v52, v52, v53
    v_max_f32 v56, v56, v57
    v_mul_f32 v52, s69, v52
    v_mul_f32 v56, s69, v56
    v_mfma_f32_32x32x16_bf16 v[80:95], a[32:35], a[68:71], v[80:95]
    buffer_load_dwordx4 v[116:119], v243, s[64:67], s5 offen offset:1024 sc1
    v_fma_f32 v160, v160, s68, v52
    v_fma_f32 v176, v176, s68, v56
    v_exp_f32 v160, v160
    v_mfma_f32_32x32x16_bf16 v[80:95], a[40:43], a[76:79], v[80:95]
    v_exp_f32 v176, v176
    v_fma_f32 v161, v161, s68, v52
    v_fma_f32 v177, v177, s68, v56
    v_exp_f32 v161, v161
    v_mfma_f32_32x32x16_bf16 v[80:95], a[48:51], a[84:87], v[80:95]
    buffer_load_dwordx4 v[120:123], v243, s[64:67], s5 offen offset:2048 sc1
    v_exp_f32 v177, v177
    v_fma_f32 v162, v162, s68, v52
    v_mfma_f32_32x32x16_bf16 v[80:95], a[56:59], a[92:95], v[80:95]
    v_fma_f32 v178, v178, s68, v56
    v_exp_f32 v162, v162
    v_exp_f32 v178, v178
    v_fma_f32 v163, v163, s68, v52
    v_mfma_f32_32x32x16_bf16 v[80:95], a[64:67], a[100:103], v[80:95]
    buffer_load_dwordx4 v[124:127], v243, s[64:67], s5 offen offset:3072 sc1
    v_fma_f32 v179, v179, s68, v56
    v_exp_f32 v163, v163
    v_mfma_f32_32x32x16_bf16 v[80:95], a[72:75], a[108:111], v[80:95]
    v_exp_f32 v179, v179
    v_add_f32 v53, v160, v161
    v_add_f32 v57, v176, v177
    v_fma_f32 v164, v164, s68, v52
    v_fma_f32 v180, v180, s68, v56
    v_mfma_f32_32x32x16_bf16 v[80:95], a[80:83], a[116:119], v[80:95]
    buffer_load_dwordx4 v[128:131], v243, s[64:67], s6 offen offset:0 sc1
    v_exp_f32 v164, v164
    v_exp_f32 v180, v180
    v_mfma_f32_32x32x16_bf16 v[80:95], a[88:91], a[124:127], v[80:95]
    v_fma_f32 v165, v165, s68, v52
    v_fma_f32 v181, v181, s68, v56
    v_exp_f32 v165, v165
    v_exp_f32 v181, v181
    v_mfma_f32_32x32x16_bf16 v[80:95], a[96:99], a[132:135], v[80:95]
    buffer_load_dwordx4 v[132:135], v243, s[64:67], s6 offen offset:1024 sc1
    v_add_f32 v54, v162, v163
    v_add_f32 v58, v178, v179
    v_fma_f32 v166, v166, s68, v52
    v_mfma_f32_32x32x16_bf16 v[80:95], a[104:107], a[140:143], v[80:95]
    v_fma_f32 v182, v182, s68, v56
    v_exp_f32 v166, v166
    v_exp_f32 v182, v182
    v_add_f32 v53, v53, v164
    v_mfma_f32_32x32x16_bf16 v[80:95], a[112:115], a[148:151], v[80:95]
    buffer_load_dwordx4 v[136:139], v243, s[64:67], s6 offen offset:2048 sc1
    v_add_f32 v57, v57, v180
    v_fma_f32 v167, v167, s68, v52
    v_fma_f32 v183, v183, s68, v56
    v_mfma_f32_32x32x16_bf16 v[80:95], a[120:123], a[156:159], v[80:95]
    v_exp_f32 v167, v167
    v_exp_f32 v183, v183
    v_add_f32 v54, v54, v165
    v_add_f32 v58, v58, v181
    v_mfma_f32_32x32x16_bf16 v[80:95], a[128:131], a[164:167], v[80:95]
    buffer_load_dwordx4 v[140:143], v243, s[64:67], s6 offen offset:3072 sc1
    v_fma_f32 v168, v168, s68, v52
    v_fma_f32 v184, v184, s68, v56
    v_exp_f32 v168, v168
    v_mfma_f32_32x32x16_bf16 v[80:95], a[136:139], a[172:175], v[80:95]
    v_exp_f32 v184, v184
    v_add_f32 v53, v53, v166
    v_add_f32 v57, v57, v182
    v_fma_f32 v169, v169, s68, v52
    v_fma_f32 v185, v185, s68, v56
    v_mfma_f32_32x32x16_bf16 v[80:95], a[144:147], a[180:183], v[80:95]
    buffer_load_dwordx4 v[144:147], v243, s[64:67], s7 offen offset:0 sc1
    v_exp_f32 v169, v169
    v_exp_f32 v185, v185
    v_mfma_f32_32x32x16_bf16 v[80:95], a[152:155], a[188:191], v[80:95]
    v_add_f32 v54, v54, v167
    v_add_f32 v58, v58, v183
    v_fma_f32 v170, v170, s68, v52
    v_fma_f32 v186, v186, s68, v56
    v_exp_f32 v170, v170
    v_mfma_f32_32x32x16_bf16 v[80:95], a[160:163], a[196:199], v[80:95]
    buffer_load_dwordx4 v[148:151], v243, s[64:67], s7 offen offset:1024 sc1
    v_exp_f32 v186, v186
    v_add_f32 v53, v53, v168
    v_mfma_f32_32x32x16_bf16 v[80:95], a[168:171], a[204:207], v[80:95]
    v_add_f32 v57, v57, v184
    v_fma_f32 v171, v171, s68, v52
    v_fma_f32 v187, v187, s68, v56
    v_exp_f32 v171, v171
    v_exp_f32 v187, v187
    v_mfma_f32_32x32x16_bf16 v[80:95], a[176:179], a[212:215], v[80:95]
    buffer_load_dwordx4 v[152:155], v243, s[64:67], s7 offen offset:2048 sc1
    v_add_f32 v54, v54, v169
    v_add_f32 v58, v58, v185
    v_fma_f32 v172, v172, s68, v52
    v_mfma_f32_32x32x16_bf16 v[80:95], a[184:187], a[220:223], v[80:95]
    v_fma_f32 v188, v188, s68, v56
    v_exp_f32 v172, v172
    v_exp_f32 v188, v188
    v_add_f32 v53, v53, v170
    v_mfma_f32_32x32x16_bf16 v[80:95], a[192:195], a[228:231], v[80:95]
    buffer_load_dwordx4 v[156:159], v243, s[64:67], s7 offen offset:3072 sc1
    s_waitcnt vmcnt(16)
    v_max3_u32 v18, v10, v11, v12
    v_max3_u32 v19, v13, v14, v15
    v_max3_u32 v18, v18, v16, v17
    v_max_u32 v18, v18, v19
    v_cmp_eq_u32 vcc, -1, v18
    s_cbranch_vccnz Lk1
Lk1d:
    v_mfma_f32_32x32x16_bf16 v[80:95], a[200:203], a[236:239], v[80:95]
    v_add_f32 v57, v57, v186
    v_fma_f32 v173, v173, s68, v52
    v_fma_f32 v189, v189, s68, v56
    v_exp_f32_e64 v173, v173
    s_add_u32 m0, s44, 36864
    s_add_u32 s52, s52, 32768
    buffer_load_dwordx4 v25, s[92:95], s52 offen lds
    v_mfma_f32_32x32x16_bf16 v[80:95], a[208:211], a[244:247], v[80:95]
    v_exp_f32_e64 v189, v189
    v_add_f32 v54, v54, v171
    v_add_f32 v58, v58, v187
    v_fma_f32 v174, v174, s68, v52
    v_fma_f32 v190, v190, s68, v56
    v_mfma_f32_32x32x16_bf16 v[80:95], a[216:219], a[252:255], v[80:95]
    v_exp_f32_e64 v174, v174
    s_add_u32 m0, s44, 40960
    s_add_u32 s52, s91, 327680
    s_cmp_eq_u32 s51, 5
    s_cselect_b32 s52, s91, s52
    buffer_load_dwordx4 v25, s[92:95], s52 offen lds
    v_exp_f32_e64 v190, v190
    v_add_f32 v53, v53, v172
    v_add_f32 v57, v57, v188
    v_fma_f32 v175, v175, s68, v52
    v_fma_f32 v191, v191, s68, v56
    v_exp_f32 v175, v175
    v_exp_f32 v191, v191
    s_add_u32 m0, s44, 45056
    s_add_u32 s52, s52, 32768
    buffer_load_dwordx4 v25, s[92:95], s52 offen lds
    v_add_f32 v54, v54, v173
    v_add_f32 v58, v58, v189
    v_add_f32 v53, v53, v174
    v_add_f32 v57, v57, v190
    v_add_f32 v54, v54, v175
    v_add_f32 v58, v58, v191
    v_add_f32 v52, v53, v54
    v_add_f32 v56, v57, v58
    v_rcp_f32 v52, v52
    v_rcp_f32 v56, v56
    s_add_u32 m0, s44, 49152
    s_add_u32 s52, s91, 393216
    s_cmp_eq_u32 s51, 6
    s_cselect_b32 s52, s91, s52
    buffer_load_dwordx4 v25, s[92:95], s52 offen lds
    v_pk_mul_f32 v[160:161], v[160:161], v[52:53] op_sel:[0,0] op_sel_hi:[1,0]
    v_pk_mul_f32 v[176:177], v[176:177], v[56:57] op_sel:[0,0] op_sel_hi:[1,0]
    v_pk_mul_f32 v[162:163], v[162:163], v[52:53] op_sel:[0,0] op_sel_hi:[1,0]
    v_pk_mul_f32 v[178:179], v[178:179], v[56:57] op_sel:[0,0] op_sel_hi:[1,0]
    v_pk_mul_f32 v[164:165], v[164:165], v[52:53] op_sel:[0,0] op_sel_hi:[1,0]
    v_pk_mul_f32 v[180:181], v[180:181], v[56:57] op_sel:[0,0] op_sel_hi:[1,0]
    v_pk_mul_f32 v[166:167], v[166:167], v[52:53] op_sel:[0,0] op_sel_hi:[1,0]
    v_pk_mul_f32 v[182:183], v[182:183], v[56:57] op_sel:[0,0] op_sel_hi:[1,0]
    v_pk_mul_f32 v[168:169], v[168:169], v[52:53] op_sel:[0,0] op_sel_hi:[1,0]
    s_add_u32 m0, s44, 53248
    s_add_u32 s52, s52, 32768
    buffer_load_dwordx4 v25, s[92:95], s52 offen lds
    v_pk_mul_f32 v[184:185], v[184:185], v[56:57] op_sel:[0,0] op_sel_hi:[1,0]
    v_pk_mul_f32 v[170:171], v[170:171], v[52:53] op_sel:[0,0] op_sel_hi:[1,0]
    v_pk_mul_f32 v[186:187], v[186:187], v[56:57] op_sel:[0,0] op_sel_hi:[1,0]
    v_pk_mul_f32 v[172:173], v[172:173], v[52:53] op_sel:[0,0] op_sel_hi:[1,0]
    v_pk_mul_f32 v[188:189], v[188:189], v[56:57] op_sel:[0,0] op_sel_hi:[1,0]
    v_pk_mul_f32 v[174:175], v[174:175], v[52:53] op_sel:[0,0] op_sel_hi:[1,0]
    v_pk_mul_f32 v[190:191], v[190:191], v[56:57] op_sel:[0,0] op_sel_hi:[1,0]
    v_cvt_pk_bf16_f32 v192, v160, v161
    v_cvt_pk_bf16_f32 v208, v176, v177
    v_cvt_pk_bf16_f32 v193, v162, v163
    v_cvt_pk_bf16_f32 v209, v178, v179
    s_add_u32 m0, s44, 57344
    s_add_u32 s52, s91, 458752
    s_cmp_eq_u32 s51, 7
    s_cselect_b32 s52, s91, s52
    buffer_load_dwordx4 v25, s[92:95], s52 offen lds
    v_cvt_pk_bf16_f32 v194, v164, v165
    v_cvt_pk_bf16_f32 v210, v180, v181
    v_cvt_pk_bf16_f32 v195, v166, v167
    v_cvt_pk_bf16_f32 v211, v182, v183
    v_cvt_pk_bf16_f32 v196, v168, v169
    v_cvt_pk_bf16_f32 v212, v184, v185
    v_cvt_pk_bf16_f32 v197, v170, v171
    v_cvt_pk_bf16_f32 v213, v186, v187
    v_cvt_pk_bf16_f32 v198, v172, v173
    s_add_u32 m0, s44, 61440
    s_add_u32 s52, s52, 32768
    buffer_load_dwordx4 v25, s[92:95], s52 offen lds
    v_cvt_pk_bf16_f32 v214, v188, v189
    v_cvt_pk_bf16_f32 v199, v174, v175
    v_cvt_pk_bf16_f32 v215, v190, v191
    v_cvt_pk_bf16_f32 v36, v80, v81
    v_cvt_pk_bf16_f32 v37, v82, v83
    v_cvt_pk_bf16_f32 v38, v84, v85
    v_cvt_pk_bf16_f32 v39, v86, v87
    v_cvt_pk_bf16_f32 v48, v88, v89
    v_cvt_pk_bf16_f32 v49, v90, v91
    v_cvt_pk_bf16_f32 v50, v92, v93
    v_cvt_pk_bf16_f32 v51, v94, v95
    v_mfma_f32_32x32x16_bf16 v[160:175], v[28:31], v[36:39], 0
    s_nop 0
    v_mfma_f32_32x32x16_bf16 v[176:191], v[32:35], v[48:51], 0
    s_cmp_lg_u32 s85, 0
    s_cbranch_scc1 Lk2
Lk2d:
    s_waitcnt vmcnt(19)
    v_add_f32 v18, v10, v11
    v_add_f32 v18, v18, v12
    v_add_f32 v18, v18, v13
    v_mfma_f32_32x32x16_bf16 v[224:239], v[96:99], v[4:7], 0
    v_add_f32 v18, v18, v14
    v_add_f32 v18, v18, v15
    v_add_f32 v18, v18, v16
    v_add_f32 v18, v18, v17
    v_mov_b32 v19, v18
    v_max3_f32 v52, v160, v161, v162
    v_mfma_f32_32x32x16_bf16 v[224:239], v[100:103], v[4:7], v[224:239]
    v_permlane32_swap_b32 v18, v19
    v_add_f32 v18, v18, v19
    v_cvt_pk_bf16_f32 v20, v18, v18
    v_max3_f32 v56, v176, v177, v178
    v_max3_f32 v53, v163, v164, v165
    v_mfma_f32_32x32x16_bf16 v[224:239], v[104:107], v[4:7], v[224:239]
    v_max3_f32 v57, v179, v180, v181
    v_max3_f32 v52, v52, v166, v167
    v_max3_f32 v56, v56, v182, v183
    v_max3_f32 v53, v53, v168, v169
    v_max3_f32 v57, v57, v184, v185
    v_mfma_f32_32x32x16_bf16 v[224:239], v[108:111], v[4:7], v[224:239]
    s_waitcnt vmcnt(15)
    v_max3_f32 v52, v52, v170, v171
    v_max3_f32 v56, v56, v186, v187
    v_max3_f32 v53, v53, v172, v173
    v_max3_f32 v57, v57, v188, v189
    v_mfma_f32_32x32x16_bf16 v[224:239], v[112:115], v[4:7], v[224:239]
    v_max3_f32 v52, v52, v174, v175
    v_max3_f32 v56, v56, v190, v191
    v_max_f32 v52, v52, v53
    v_max_f32 v56, v56, v57
    v_mul_f32 v52, s69, v52
    v_mul_f32_e64 v56, s69, v56
    v_mfma_f32_32x32x16_bf16 v[224:239], v[116:119], v[4:7], v[224:239]
    v_fma_f32 v160, v160, s68, v52
    v_fma_f32 v176, v176, s68, v56
    v_exp_f32 v160, v160
    v_exp_f32 v176, v176
    v_mfma_f32_32x32x16_bf16 v[224:239], v[120:123], v[4:7], v[224:239]
    v_fma_f32 v161, v161, s68, v52
    v_fma_f32 v177, v177, s68, v56
    v_exp_f32_e64 v161, v161
    v_exp_f32 v177, v177
    v_mfma_f32_32x32x16_bf16 v[224:239], v[124:127], v[4:7], v[224:239]
    s_waitcnt vmcnt(11)
    v_fma_f32 v162, v162, s68, v52
    v_fma_f32 v178, v178, s68, v56
    v_exp_f32 v162, v162
    v_exp_f32 v178, v178
    v_mfma_f32_32x32x16_bf16 v[224:239], v[128:131], v[4:7], v[224:239]
    v_fma_f32 v163, v163, s68, v52
    v_fma_f32 v179, v179, s68, v56
    v_exp_f32 v163, v163
    v_exp_f32 v179, v179
    v_mfma_f32_32x32x16_bf16 v[224:239], v[132:135], v[4:7], v[224:239]
    v_add_f32 v53, v160, v161
    v_add_f32 v57, v176, v177
    v_fma_f32 v164, v164, s68, v52
    v_fma_f32 v180, v180, s68, v56
    v_exp_f32 v164, v164
    v_mfma_f32_32x32x16_bf16 v[224:239], v[136:139], v[4:7], v[224:239]
    v_exp_f32 v180, v180
    v_fma_f32 v165, v165, s68, v52
    v_fma_f32 v181, v181, s68, v56
    v_exp_f32 v165, v165
    v_mfma_f32_32x32x16_bf16 v[224:239], v[140:143], v[4:7], v[224:239]
    s_waitcnt vmcnt(7)
    v_exp_f32 v181, v181
    v_add_f32 v54, v162, v163
    v_add_f32_e64 v58, v178, v179
    v_fma_f32 v166, v166, s68, v52
    v_mfma_f32_32x32x16_bf16 v[224:239], v[144:147], v[4:7], v[224:239]
    v_fma_f32 v182, v182, s68, v56
    v_exp_f32 v166, v166
    v_exp_f32 v182, v182
    v_add_f32 v53, v53, v164
    v_mfma_f32_32x32x16_bf16 v[224:239], v[148:151], v[4:7], v[224:239]
    v_add_f32 v57, v57, v180
    v_fma_f32 v167, v167, s68, v52
    v_fma_f32 v183, v183, s68, v56
    v_exp_f32 v167, v167
    v_exp_f32 v183, v183
    v_mfma_f32_32x32x16_bf16 v[224:239], v[152:155], v[4:7], v[224:239]
    v_add_f32 v54, v54, v165
    v_add_f32 v58, v58, v181
    v_fma_f32 v168, v168, s68, v52
    v_fma_f32 v184, v184, s68, v56
    v_exp_f32 v168, v168
    v_mfma_f32_32x32x16_bf16 v[224:239], v[156:159], v[4:7], v[224:239]
    v_exp_f32 v184, v184
    v_add_f32 v53, v53, v166
    v_add_f32 v57, v57, v182
    v_fma_f32 v169, v169, s68, v52
    v_fma_f32 v185, v185, s68, v56
    v_mfma_f32_32x32x16_bf16 v[224:239], v[20:23], v[252:255], v[224:239]
    v_exp_f32 v169, v169
    v_exp_f32 v185, v185
    v_add_f32 v54, v54, v167
    v_add_f32 v58, v58, v183
    v_fma_f32 v170, v170, s68, v52
    v_fma_f32 v186, v186, s68, v56
    v_exp_f32 v170, v170
    v_exp_f32 v186, v186
    v_add_f32 v53, v53, v168
    v_add_f32 v57, v57, v184
    v_fma_f32 v171, v171, s68, v52
    v_fma_f32 v187, v187, s68, v56
    v_cvt_pk_bf16_f32 v72, v224, v225
    v_cvt_pk_bf16_f32 v73, v226, v227
    v_cvt_pk_bf16_f32 v74, v228, v229
    v_cvt_pk_bf16_f32 v75, v230, v231
    v_cvt_pk_bf16_f32 v76, v232, v233
    v_cvt_pk_bf16_f32 v77, v234, v235
    v_cvt_pk_bf16_f32 v78, v236, v237
    v_cvt_pk_bf16_f32 v79, v238, v239
    v_mfma_f32_32x32x16_bf16 v[224:239], v[72:75], v[208:211], 0
    v_exp_f32 v171, v171
    v_exp_f32 v187, v187
    v_add_f32 v54, v54, v169
    v_add_f32 v58, v58, v185
    v_mfma_f32_32x32x16_bf16 v[224:239], v[76:79], v[212:215], v[224:239]
    v_fma_f32 v172, v172, s68, v52
    v_fma_f32 v188, v188, s68, v56
    v_exp_f32 v172, v172
    v_exp_f32 v188, v188
    v_add_f32 v53, v53, v170
    v_add_f32 v57, v57, v186
    v_fma_f32 v173, v173, s68, v52
    v_fma_f32 v189, v189, s68, v56
    v_exp_f32 v173, v173
    v_exp_f32 v189, v189
    v_add_f32 v54, v54, v171
    v_add_f32 v58, v58, v187
    v_add_f32 v232, 0x358637bd, v232
    v_cmp_u_f32 vcc, v224, v232
    s_cbranch_vccnz Lk3
Lk3d:
    ds_write_b128 v241, v[72:75] offset:4096
    ds_write_b128 v241, v[76:79] offset:5120
    v_rcp_f32_e64 v232, v232
    v_fma_f32 v174, v174, s68, v52
    v_pk_mul_f32 v[224:225], v[224:225], v[232:233] op_sel:[0,0] op_sel_hi:[1,0]
    v_pk_mul_f32 v[226:227], v[226:227], v[232:233] op_sel:[0,0] op_sel_hi:[1,0]
    v_pk_mul_f32 v[228:229], v[228:229], v[232:233] op_sel:[0,0] op_sel_hi:[1,0]
    v_pk_mul_f32 v[230:231], v[230:231], v[232:233] op_sel:[0,0] op_sel_hi:[1,0]
    v_cvt_pk_bf16_f32 v236, v224, v225
    v_cvt_pk_bf16_f32 v237, v226, v227
    v_cvt_pk_bf16_f32 v238, v228, v229
    v_cvt_pk_bf16_f32 v239, v230, v231
    buffer_store_dwordx4 v[236:239], v26, s[36:39], s21 offen sc1
    ds_write_b128 v61, v[236:239] offset:0
    s_waitcnt lgkmcnt(1)
    s_barrier
    ds_read_b128 v[64:67], v2 offset:4096
    ds_read_b128 v[68:71], v2 offset:5120
    v_fma_f32 v190, v190, s68, v56
    v_exp_f32 v174, v174
    v_exp_f32 v190, v190
    v_add_f32 v53, v53, v172
    v_add_f32 v57, v57, v188
    v_fma_f32 v175, v175, s68, v52
    v_fma_f32 v191, v191, s68, v56
    v_exp_f32 v175, v175
    v_exp_f32 v191, v191
    v_add_f32 v54, v54, v173
    v_add_f32 v58, v58, v189
    v_add_f32 v53, v53, v174
    v_add_f32 v57, v57, v190
    v_add_f32 v54, v54, v175
    v_add_f32 v58, v58, v191
    v_add_f32 v52, v53, v54
    v_add_f32 v56, v57, v58
    v_rcp_f32 v52, v52
    v_rcp_f32 v56, v56
    v_pk_mul_f32 v[160:161], v[160:161], v[52:53] op_sel:[0,0] op_sel_hi:[1,0]
    s_waitcnt lgkmcnt(0)
    v_mfma_f32_32x32x16_bf16 v[96:111], v[64:67], v[192:195], 0
    v_mfma_f32_32x32x16_bf16 v[96:111], v[68:71], v[196:199], v[96:111]
    s_nop 5
    v_pk_mul_f32 v[176:177], v[176:177], v[56:57] op_sel:[0,0] op_sel_hi:[1,0]
    v_pk_mul_f32 v[162:163], v[162:163], v[52:53] op_sel:[0,0] op_sel_hi:[1,0]
    v_pk_mul_f32 v[178:179], v[178:179], v[56:57] op_sel:[0,0] op_sel_hi:[1,0]
    v_pk_mul_f32 v[164:165], v[164:165], v[52:53] op_sel:[0,0] op_sel_hi:[1,0]
    v_pk_mul_f32 v[180:181], v[180:181], v[56:57] op_sel:[0,0] op_sel_hi:[1,0]
    v_pk_mul_f32 v[166:167], v[166:167], v[52:53] op_sel:[0,0] op_sel_hi:[1,0]
    v_add_f32 v104, 0x358637bd, v104
    v_rcp_f32_e64 v104, v104
    v_pk_mul_f32 v[182:183], v[182:183], v[56:57] op_sel:[0,0] op_sel_hi:[1,0]
    v_pk_mul_f32 v[96:97], v[96:97], v[104:105] op_sel:[0,0] op_sel_hi:[1,0]
    v_pk_mul_f32 v[98:99], v[98:99], v[104:105] op_sel:[0,0] op_sel_hi:[1,0]
    v_pk_mul_f32 v[100:101], v[100:101], v[104:105] op_sel:[0,0] op_sel_hi:[1,0]
    v_pk_mul_f32 v[102:103], v[102:103], v[104:105] op_sel:[0,0] op_sel_hi:[1,0]
    v_cvt_pk_bf16_f32 v108, v96, v97
    v_cvt_pk_bf16_f32 v109, v98, v99
    v_cvt_pk_bf16_f32 v110, v100, v101
    v_cvt_pk_bf16_f32 v111, v102, v103
    buffer_store_dwordx4 v[108:111], v26, s[36:39], s88 offen sc1
    ds_write_b128 v60, v[108:111] offset:0
    v_pk_mul_f32 v[168:169], v[168:169], v[52:53] op_sel:[0,0] op_sel_hi:[1,0]
    v_pk_mul_f32 v[184:185], v[184:185], v[56:57] op_sel:[0,0] op_sel_hi:[1,0]
    v_pk_mul_f32 v[170:171], v[170:171], v[52:53] op_sel:[0,0] op_sel_hi:[1,0]
    v_pk_mul_f32 v[186:187], v[186:187], v[56:57] op_sel:[0,0] op_sel_hi:[1,0]
    v_pk_mul_f32 v[172:173], v[172:173], v[52:53] op_sel:[0,0] op_sel_hi:[1,0]
    v_pk_mul_f32 v[188:189], v[188:189], v[56:57] op_sel:[0,0] op_sel_hi:[1,0]
    v_pk_mul_f32 v[174:175], v[174:175], v[52:53] op_sel:[0,0] op_sel_hi:[1,0]
    v_pk_mul_f32 v[190:191], v[190:191], v[56:57] op_sel:[0,0] op_sel_hi:[1,0]
    v_cvt_pk_bf16_f32 v200, v160, v161
    v_cvt_pk_bf16_f32 v216, v176, v177
    v_cvt_pk_bf16_f32 v201, v162, v163
    v_cvt_pk_bf16_f32 v217, v178, v179
    v_cvt_pk_bf16_f32 v202, v164, v165
    v_cvt_pk_bf16_f32 v218, v180, v181
    v_cvt_pk_bf16_f32 v203, v166, v167
    v_cvt_pk_bf16_f32 v219, v182, v183
    v_cvt_pk_bf16_f32 v204, v168, v169
    v_cvt_pk_bf16_f32 v220, v184, v185
    v_cvt_pk_bf16_f32 v205, v170, v171
    v_cvt_pk_bf16_f32 v221, v186, v187
    v_cvt_pk_bf16_f32 v206, v172, v173
    v_cvt_pk_bf16_f32 v222, v188, v189
    v_cvt_pk_bf16_f32 v207, v174, v175
    v_cvt_pk_bf16_f32 v223, v190, v191
    v_mfma_f32_32x32x16_bf16 v[144:159], v[72:75], v[216:219], 0
    s_nop 0
    v_mfma_f32_32x32x16_bf16 v[144:159], v[76:79], v[220:223], v[144:159]
    v_mfma_f32_32x32x16_bf16 v[112:127], v[64:67], v[200:203], 0
    v_mfma_f32_32x32x16_bf16 v[112:127], v[68:71], v[204:207], v[112:127]
    s_nop 9
    v_add_f32 v152, 0x358637bd, v152
    v_rcp_f32 v152, v152
    s_nop 0
    v_mul_f32 v144, v152, v144
    v_mul_f32 v145, v152, v145
    v_mul_f32 v146, v152, v146
    v_mul_f32 v147, v152, v147
    v_mul_f32 v148, v152, v148
    v_mul_f32 v149, v152, v149
    v_mul_f32 v150, v152, v150
    v_mul_f32 v151, v152, v151
    v_cvt_pk_bf16_f32 v156, v144, v145
    v_cvt_pk_bf16_f32 v157, v146, v147
    v_cvt_pk_bf16_f32 v158, v148, v149
    v_cvt_pk_bf16_f32 v159, v150, v151
    buffer_store_dwordx4 v[156:159], v26, s[36:39], s22 offen sc1
    ds_write_b128 v61, v[156:159] offset:2048
    v_add_f32 v120, 0x358637bd, v120
    v_rcp_f32 v120, v120
    s_nop 0
    v_pk_mul_f32 v[112:113], v[112:113], v[120:121] op_sel:[0,0] op_sel_hi:[1,0]
    v_pk_mul_f32 v[114:115], v[114:115], v[120:121] op_sel:[0,0] op_sel_hi:[1,0]
    v_pk_mul_f32 v[116:117], v[116:117], v[120:121] op_sel:[0,0] op_sel_hi:[1,0]
    v_pk_mul_f32 v[118:119], v[118:119], v[120:121] op_sel:[0,0] op_sel_hi:[1,0]
    v_cvt_pk_bf16_f32 v124, v112, v113
    v_cvt_pk_bf16_f32 v125, v114, v115
    v_cvt_pk_bf16_f32 v126, v116, v117
    v_cvt_pk_bf16_f32 v127, v118, v119
    buffer_store_dwordx4 v[124:127], v26, s[36:39], s89 offen sc1
    ds_write_b128 v60, v[124:127] offset:2048
    v_mov_b32_e64 v2, s32
    s_lshl_b32 s58, s63, 6
    v_xor_b32 v7, s58, v63
    v_add_u32 v7, 0, v7
    v_xor_b32 v8, 64, v7
    s_lshl_b32 s58, s63, 11
    s_lshl_b32 s56, s62, 14
    s_add_u32 s58, s58, s56
    s_add_u32 s58, s58, 65536
    v_add_u32 v62, s58, v26
    v_and_b32 v6, 1, v1
    v_cmp_eq_u32 vcc, 0, v6
    v_mov_b32 v4, 0x07060c0c
    v_mov_b32 v5, 0x01000c0c
    v_cndmask_b32_e64 v249, v4, v5, vcc
    v_mov_b32 v4, 0x03020c0c
    v_mov_b32 v5, 0x05040c0c
    v_cndmask_b32_e64 v250, v4, v5, vcc
    s_waitcnt vmcnt(0)
    s_mov_b64 exec, 1
    s_cmp_lg_u32 s23, 0
    s_cbranch_scc1 Lfs_5
    buffer_store_dword v246, v2, s[36:39], s87 offen
    s_branch Lfe_6
Lfs_5:
    buffer_store_dword v246, v2, s[36:39], s87 offen sc1
Lfe_6:
    s_mov_b64 exec, -1
    s_waitcnt lgkmcnt(0)
    s_barrier
    ds_read_b128 a[0:3], v62 offset:0
    ds_read_b128 a[4:7], v62 offset:1024
    ds_read_b128 a[8:11], v62 offset:8192
    ds_read_b128 a[12:15], v62 offset:9216
    ds_read_b64_tr_b16 v[160:161], v7 offset:0
    ds_read_b64_tr_b16 v[162:163], v7 offset:512
    ds_read_b64_tr_b16 v[164:165], v8 offset:0
    ds_read_b64_tr_b16 v[166:167], v8 offset:512
    ds_read_b64_tr_b16 v[168:169], v7 offset:2048
    ds_read_b64_tr_b16 v[170:171], v7 offset:2560
    ds_read_b64_tr_b16 v[172:173], v8 offset:2048
    ds_read_b64_tr_b16 v[174:175], v8 offset:2560
    ds_read_b64_tr_b16 v[176:177], v7 offset:4096
    ds_read_b64_tr_b16 v[178:179], v7 offset:4608
    ds_read_b64_tr_b16 v[180:181], v8 offset:4096
    ds_read_b64_tr_b16 v[182:183], v8 offset:4608
    s_mov_b32 s59, 262144
Lpf_7:
    buffer_load_dword v4, v245, s[36:39], s87 offen sc1
    s_waitcnt vmcnt(0)
    v_cmp_ne_u32_e64 vcc, s3, v4
    s_cbranch_vccz Lpfd_8
    s_sub_u32 s59, s59, 1
    s_cmp_eq_u32 s59, 0
    s_cbranch_scc1 Lpfd_8
    s_branch Lpf_7
Lpfd_8:
    s_cmp_eq_u32 s51, 1
    s_cselect_b32 s57, 0, 4096
    s_add_u32 s57, s57, s90
    buffer_load_dwordx4 a[16:19], v26, s[36:39], s57 offen offset:0 sc1
    buffer_load_dwordx4 a[20:23], v26, s[36:39], s57 offen offset:1024 sc1
    buffer_load_dwordx4 a[24:27], v26, s[36:39], s57 offen offset:2048 sc1
    buffer_load_dwordx4 a[28:31], v26, s[36:39], s57 offen offset:3072 sc1
    s_cmp_eq_u32 s51, 2
    s_cselect_b32 s57, 0, 8192
    s_add_u32 s57, s57, s90
    buffer_load_dwordx4 a[32:35], v26, s[36:39], s57 offen offset:0 sc1
    buffer_load_dwordx4 a[36:39], v26, s[36:39], s57 offen offset:1024 sc1
    buffer_load_dwordx4 a[40:43], v26, s[36:39], s57 offen offset:2048 sc1
    buffer_load_dwordx4 a[44:47], v26, s[36:39], s57 offen offset:3072 sc1
    s_cmp_eq_u32 s51, 3
    s_cselect_b32 s57, 0, 12288
    s_add_u32 s57, s57, s90
    buffer_load_dwordx4 a[48:51], v26, s[36:39], s57 offen offset:0 sc1
    buffer_load_dwordx4 a[52:55], v26, s[36:39], s57 offen offset:1024 sc1
    buffer_load_dwordx4 a[56:59], v26, s[36:39], s57 offen offset:2048 sc1
    buffer_load_dwordx4 a[60:63], v26, s[36:39], s57 offen offset:3072 sc1
    s_waitcnt lgkmcnt(8)
    v_mfma_f32_32x32x16_bf16 v[64:79], a[0:3], v[160:163], 0
    ds_read_b64_tr_b16 v[184:185], v7 offset:6144
    ds_read_b64_tr_b16 v[186:187], v7 offset:6656
    v_mfma_f32_32x32x16_bf16 v[80:95], a[0:3], v[164:167], 0
    ds_read_b64_tr_b16 v[188:189], v8 offset:6144
    ds_read_b64_tr_b16 v[190:191], v8 offset:6656
    s_waitcnt lgkmcnt(8)
    v_mfma_f32_32x32x16_bf16 v[64:79], a[4:7], v[168:171], v[64:79]
    ds_read_b64_tr_b16 v[160:161], v7 offset:8192
    ds_read_b64_tr_b16 v[162:163], v7 offset:8704
    v_mfma_f32_32x32x16_bf16 v[80:95], a[4:7], v[172:175], v[80:95]
    ds_read_b64_tr_b16 v[164:165], v8 offset:8192
    ds_read_b64_tr_b16 v[166:167], v8 offset:8704
    s_waitcnt lgkmcnt(8)
    v_mfma_f32_32x32x16_bf16 v[64:79], a[8:11], v[176:179], v[64:79]
    ds_read_b64_tr_b16 v[168:169], v7 offset:10240
    ds_read_b64_tr_b16 v[170:171], v7 offset:10752
    v_mfma_f32_32x32x16_bf16 v[80:95], a[8:11], v[180:183], v[80:95]
    ds_read_b64_tr_b16 v[172:173], v8 offset:10240
    ds_read_b64_tr_b16 v[174:175], v8 offset:10752
    s_waitcnt lgkmcnt(8)
    v_mfma_f32_32x32x16_bf16 v[64:79], a[12:15], v[184:187], v[64:79]
    ds_read_b64_tr_b16 v[176:177], v7 offset:12288
    ds_read_b64_tr_b16 v[178:179], v7 offset:12800
    v_mfma_f32_32x32x16_bf16 v[80:95], a[12:15], v[188:191], v[80:95]
    ds_read_b64_tr_b16 v[180:181], v8 offset:12288
    ds_read_b64_tr_b16 v[182:183], v8 offset:12800
    s_waitcnt vmcnt(11) lgkmcnt(8)
    v_mfma_f32_32x32x16_bf16 v[64:79], a[16:19], v[160:163], v[64:79]
    ds_read_b64_tr_b16 v[184:185], v7 offset:14336
    ds_read_b64_tr_b16 v[186:187], v7 offset:14848
    s_cmp_eq_u32 s51, 4
    s_cselect_b32 s57, 0, 16384
    s_add_u32 s57, s57, s90
    buffer_load_dwordx4 a[64:67], v26, s[36:39], s57 offen offset:0 sc1
    v_mfma_f32_32x32x16_bf16 v[80:95], a[16:19], v[164:167], v[80:95]
    ds_read_b64_tr_b16 v[188:189], v8 offset:14336
    ds_read_b64_tr_b16 v[190:191], v8 offset:14848
    s_waitcnt vmcnt(11) lgkmcnt(8)
    v_mfma_f32_32x32x16_bf16 v[64:79], a[20:23], v[168:171], v[64:79]
    ds_read_b64_tr_b16 v[160:161], v7 offset:16384
    ds_read_b64_tr_b16 v[162:163], v7 offset:16896
    buffer_load_dwordx4 a[68:71], v26, s[36:39], s57 offen offset:1024 sc1
    v_mfma_f32_32x32x16_bf16 v[80:95], a[20:23], v[172:175], v[80:95]
    ds_read_b64_tr_b16 v[164:165], v8 offset:16384
    ds_read_b64_tr_b16 v[166:167], v8 offset:16896
    s_waitcnt vmcnt(11) lgkmcnt(8)
    v_mfma_f32_32x32x16_bf16 v[64:79], a[24:27], v[176:179], v[64:79]
    ds_read_b64_tr_b16 v[168:169], v7 offset:18432
    ds_read_b64_tr_b16 v[170:171], v7 offset:18944
    buffer_load_dwordx4 a[72:75], v26, s[36:39], s57 offen offset:2048 sc1
    v_mfma_f32_32x32x16_bf16 v[80:95], a[24:27], v[180:183], v[80:95]
    ds_read_b64_tr_b16 v[172:173], v8 offset:18432
    ds_read_b64_tr_b16 v[174:175], v8 offset:18944
    s_waitcnt vmcnt(11) lgkmcnt(8)
    v_mfma_f32_32x32x16_bf16 v[64:79], a[28:31], v[184:187], v[64:79]
    ds_read_b64_tr_b16 v[176:177], v7 offset:20480
    ds_read_b64_tr_b16 v[178:179], v7 offset:20992
    buffer_load_dwordx4 a[76:79], v26, s[36:39], s57 offen offset:3072 sc1
    v_mfma_f32_32x32x16_bf16 v[80:95], a[28:31], v[188:191], v[80:95]
    ds_read_b64_tr_b16 v[180:181], v8 offset:20480
    ds_read_b64_tr_b16 v[182:183], v8 offset:20992
    s_waitcnt vmcnt(11) lgkmcnt(8)
    v_mfma_f32_32x32x16_bf16 v[64:79], a[32:35], v[160:163], v[64:79]
    ds_read_b64_tr_b16 v[184:185], v7 offset:22528
    ds_read_b64_tr_b16 v[186:187], v7 offset:23040
    s_cmp_eq_u32 s51, 5
    s_cselect_b32 s57, 0, 20480
    s_add_u32 s57, s57, s90
    buffer_load_dwordx4 a[80:83], v26, s[36:39], s57 offen offset:0 sc1
    v_mfma_f32_32x32x16_bf16 v[80:95], a[32:35], v[164:167], v[80:95]
    ds_read_b64_tr_b16 v[188:189], v8 offset:22528
    ds_read_b64_tr_b16 v[190:191], v8 offset:23040
    s_waitcnt vmcnt(11) lgkmcnt(8)
    v_mfma_f32_32x32x16_bf16 v[64:79], a[36:39], v[168:171], v[64:79]
    ds_read_b64_tr_b16 v[160:161], v7 offset:24576
    ds_read_b64_tr_b16 v[162:163], v7 offset:25088
    buffer_load_dwordx4 a[84:87], v26, s[36:39], s57 offen offset:1024 sc1
    v_mfma_f32_32x32x16_bf16 v[80:95], a[36:39], v[172:175], v[80:95]
    ds_read_b64_tr_b16 v[164:165], v8 offset:24576
    ds_read_b64_tr_b16 v[166:167], v8 offset:25088
    s_waitcnt vmcnt(11) lgkmcnt(8)
    v_mfma_f32_32x32x16_bf16 v[64:79], a[40:43], v[176:179], v[64:79]
    ds_read_b64_tr_b16 v[168:169], v7 offset:26624
    ds_read_b64_tr_b16 v[170:171], v7 offset:27136
    buffer_load_dwordx4 a[88:91], v26, s[36:39], s57 offen offset:2048 sc1
    v_mfma_f32_32x32x16_bf16 v[80:95], a[40:43], v[180:183], v[80:95]
    ds_read_b64_tr_b16 v[172:173], v8 offset:26624
    ds_read_b64_tr_b16 v[174:175], v8 offset:27136
    s_waitcnt vmcnt(11) lgkmcnt(8)
    v_mfma_f32_32x32x16_bf16 v[64:79], a[44:47], v[184:187], v[64:79]
    ds_read_b64_tr_b16 v[176:177], v7 offset:28672
    ds_read_b64_tr_b16 v[178:179], v7 offset:29184
    buffer_load_dwordx4 a[92:95], v26, s[36:39], s57 offen offset:3072 sc1
    v_mfma_f32_32x32x16_bf16 v[80:95], a[44:47], v[188:191], v[80:95]
    ds_read_b64_tr_b16 v[180:181], v8 offset:28672
    ds_read_b64_tr_b16 v[182:183], v8 offset:29184
    s_waitcnt vmcnt(11) lgkmcnt(8)
    v_mfma_f32_32x32x16_bf16 v[64:79], a[48:51], v[160:163], v[64:79]
    ds_read_b64_tr_b16 v[184:185], v7 offset:30720
    ds_read_b64_tr_b16 v[186:187], v7 offset:31232
    s_cmp_eq_u32 s51, 6
    s_cselect_b32 s57, 0, 24576
    s_add_u32 s57, s57, s90
    buffer_load_dwordx4 a[96:99], v26, s[36:39], s57 offen offset:0 sc1
    v_mfma_f32_32x32x16_bf16 v[80:95], a[48:51], v[164:167], v[80:95]
    ds_read_b64_tr_b16 v[188:189], v8 offset:30720
    ds_read_b64_tr_b16 v[190:191], v8 offset:31232
    s_waitcnt vmcnt(11) lgkmcnt(8)
    v_mfma_f32_32x32x16_bf16 v[64:79], a[52:55], v[168:171], v[64:79]
    ds_read_b64_tr_b16 v[160:161], v7 offset:32768
    ds_read_b64_tr_b16 v[162:163], v7 offset:33280
    buffer_load_dwordx4 a[100:103], v26, s[36:39], s57 offen offset:1024 sc1
    v_mfma_f32_32x32x16_bf16 v[80:95], a[52:55], v[172:175], v[80:95]
    ds_read_b64_tr_b16 v[164:165], v8 offset:32768
    ds_read_b64_tr_b16 v[166:167], v8 offset:33280
    s_waitcnt vmcnt(11) lgkmcnt(8)
    v_mfma_f32_32x32x16_bf16 v[64:79], a[56:59], v[176:179], v[64:79]
    ds_read_b64_tr_b16 v[168:169], v7 offset:34816
    ds_read_b64_tr_b16 v[170:171], v7 offset:35328
    buffer_load_dwordx4 a[104:107], v26, s[36:39], s57 offen offset:2048 sc1
    v_mfma_f32_32x32x16_bf16 v[80:95], a[56:59], v[180:183], v[80:95]
    ds_read_b64_tr_b16 v[172:173], v8 offset:34816
    ds_read_b64_tr_b16 v[174:175], v8 offset:35328
    s_waitcnt vmcnt(11) lgkmcnt(8)
    v_mfma_f32_32x32x16_bf16 v[64:79], a[60:63], v[184:187], v[64:79]
    ds_read_b64_tr_b16 v[176:177], v7 offset:36864
    ds_read_b64_tr_b16 v[178:179], v7 offset:37376
    buffer_load_dwordx4 a[108:111], v26, s[36:39], s57 offen offset:3072 sc1
    v_mfma_f32_32x32x16_bf16 v[80:95], a[60:63], v[188:191], v[80:95]
    ds_read_b64_tr_b16 v[180:181], v8 offset:36864
    ds_read_b64_tr_b16 v[182:183], v8 offset:37376
    s_waitcnt vmcnt(11) lgkmcnt(8)
    v_mfma_f32_32x32x16_bf16 v[64:79], a[64:67], v[160:163], v[64:79]
    ds_read_b64_tr_b16 v[184:185], v7 offset:38912
    ds_read_b64_tr_b16 v[186:187], v7 offset:39424
    s_cmp_eq_u32 s51, 7
    s_cselect_b32 s57, 0, 28672
    s_add_u32 s57, s57, s90
    buffer_load_dwordx4 a[112:115], v26, s[36:39], s57 offen offset:0 sc1
    v_mfma_f32_32x32x16_bf16 v[80:95], a[64:67], v[164:167], v[80:95]
    ds_read_b64_tr_b16 v[188:189], v8 offset:38912
    ds_read_b64_tr_b16 v[190:191], v8 offset:39424
    s_waitcnt vmcnt(11) lgkmcnt(8)
    v_mfma_f32_32x32x16_bf16 v[64:79], a[68:71], v[168:171], v[64:79]
    ds_read_b64_tr_b16 v[160:161], v7 offset:40960
    ds_read_b64_tr_b16 v[162:163], v7 offset:41472
    buffer_load_dwordx4 a[116:119], v26, s[36:39], s57 offen offset:1024 sc1
    v_mfma_f32_32x32x16_bf16 v[80:95], a[68:71], v[172:175], v[80:95]
    ds_read_b64_tr_b16 v[164:165], v8 offset:40960
    ds_read_b64_tr_b16 v[166:167], v8 offset:41472
    s_waitcnt vmcnt(11) lgkmcnt(8)
    v_mfma_f32_32x32x16_bf16 v[64:79], a[72:75], v[176:179], v[64:79]
    ds_read_b64_tr_b16 v[168:169], v7 offset:43008
    ds_read_b64_tr_b16 v[170:171], v7 offset:43520
    buffer_load_dwordx4 a[120:123], v26, s[36:39], s57 offen offset:2048 sc1
    v_mfma_f32_32x32x16_bf16 v[80:95], a[72:75], v[180:183], v[80:95]
    ds_read_b64_tr_b16 v[172:173], v8 offset:43008
    ds_read_b64_tr_b16 v[174:175], v8 offset:43520
    s_waitcnt vmcnt(11) lgkmcnt(8)
    v_mfma_f32_32x32x16_bf16 v[64:79], a[76:79], v[184:187], v[64:79]
    ds_read_b64_tr_b16 v[176:177], v7 offset:45056
    ds_read_b64_tr_b16 v[178:179], v7 offset:45568
    buffer_load_dwordx4 a[124:127], v26, s[36:39], s57 offen offset:3072 sc1
    v_mfma_f32_32x32x16_bf16 v[80:95], a[76:79], v[188:191], v[80:95]
    ds_read_b64_tr_b16 v[180:181], v8 offset:45056
    ds_read_b64_tr_b16 v[182:183], v8 offset:45568
    s_waitcnt vmcnt(11) lgkmcnt(8)
    v_mfma_f32_32x32x16_bf16 v[64:79], a[80:83], v[160:163], v[64:79]
    ds_read_b64_tr_b16 v[184:185], v7 offset:47104
    ds_read_b64_tr_b16 v[186:187], v7 offset:47616
    v_mfma_f32_32x32x16_bf16 v[80:95], a[80:83], v[164:167], v[80:95]
    ds_read_b64_tr_b16 v[188:189], v8 offset:47104
    ds_read_b64_tr_b16 v[190:191], v8 offset:47616
    s_waitcnt vmcnt(10) lgkmcnt(8)
    v_mfma_f32_32x32x16_bf16 v[64:79], a[84:87], v[168:171], v[64:79]
    ds_read_b64_tr_b16 v[160:161], v7 offset:49152
    ds_read_b64_tr_b16 v[162:163], v7 offset:49664
    v_mfma_f32_32x32x16_bf16 v[80:95], a[84:87], v[172:175], v[80:95]
    ds_read_b64_tr_b16 v[164:165], v8 offset:49152
    ds_read_b64_tr_b16 v[166:167], v8 offset:49664
    s_waitcnt vmcnt(9) lgkmcnt(8)
    v_mfma_f32_32x32x16_bf16 v[64:79], a[88:91], v[176:179], v[64:79]
    ds_read_b64_tr_b16 v[168:169], v7 offset:51200
    ds_read_b64_tr_b16 v[170:171], v7 offset:51712
    v_mfma_f32_32x32x16_bf16 v[80:95], a[88:91], v[180:183], v[80:95]
    ds_read_b64_tr_b16 v[172:173], v8 offset:51200
    ds_read_b64_tr_b16 v[174:175], v8 offset:51712
    s_waitcnt vmcnt(8) lgkmcnt(8)
    v_mfma_f32_32x32x16_bf16 v[64:79], a[92:95], v[184:187], v[64:79]
    ds_read_b64_tr_b16 v[176:177], v7 offset:53248
    ds_read_b64_tr_b16 v[178:179], v7 offset:53760
    v_mfma_f32_32x32x16_bf16 v[80:95], a[92:95], v[188:191], v[80:95]
    ds_read_b64_tr_b16 v[180:181], v8 offset:53248
    ds_read_b64_tr_b16 v[182:183], v8 offset:53760
    s_waitcnt vmcnt(7) lgkmcnt(8)
    v_mfma_f32_32x32x16_bf16 v[64:79], a[96:99], v[160:163], v[64:79]
    ds_read_b64_tr_b16 v[184:185], v7 offset:55296
    ds_read_b64_tr_b16 v[186:187], v7 offset:55808
    v_mfma_f32_32x32x16_bf16 v[80:95], a[96:99], v[164:167], v[80:95]
    ds_read_b64_tr_b16 v[188:189], v8 offset:55296
    ds_read_b64_tr_b16 v[190:191], v8 offset:55808
    s_waitcnt vmcnt(6) lgkmcnt(8)
    v_mfma_f32_32x32x16_bf16 v[64:79], a[100:103], v[168:171], v[64:79]
    ds_read_b64_tr_b16 v[160:161], v7 offset:57344
    ds_read_b64_tr_b16 v[162:163], v7 offset:57856
    v_mfma_f32_32x32x16_bf16 v[80:95], a[100:103], v[172:175], v[80:95]
    ds_read_b64_tr_b16 v[164:165], v8 offset:57344
    ds_read_b64_tr_b16 v[166:167], v8 offset:57856
    s_waitcnt vmcnt(5) lgkmcnt(8)
    v_mfma_f32_32x32x16_bf16 v[64:79], a[104:107], v[176:179], v[64:79]
    ds_read_b64_tr_b16 v[168:169], v7 offset:59392
    ds_read_b64_tr_b16 v[170:171], v7 offset:59904
    v_mfma_f32_32x32x16_bf16 v[80:95], a[104:107], v[180:183], v[80:95]
    ds_read_b64_tr_b16 v[172:173], v8 offset:59392
    ds_read_b64_tr_b16 v[174:175], v8 offset:59904
    s_waitcnt vmcnt(4) lgkmcnt(8)
    v_mfma_f32_32x32x16_bf16 v[64:79], a[108:111], v[184:187], v[64:79]
    ds_read_b64_tr_b16 v[176:177], v7 offset:61440
    ds_read_b64_tr_b16 v[178:179], v7 offset:61952
    v_mfma_f32_32x32x16_bf16 v[80:95], a[108:111], v[188:191], v[80:95]
    ds_read_b64_tr_b16 v[180:181], v8 offset:61440
    ds_read_b64_tr_b16 v[182:183], v8 offset:61952
    s_waitcnt vmcnt(3) lgkmcnt(8)
    v_mfma_f32_32x32x16_bf16 v[64:79], a[112:115], v[160:163], v[64:79]
    ds_read_b64_tr_b16 v[184:185], v7 offset:63488
    ds_read_b64_tr_b16 v[186:187], v7 offset:64000
    v_mfma_f32_32x32x16_bf16 v[80:95], a[112:115], v[164:167], v[80:95]
    ds_read_b64_tr_b16 v[188:189], v8 offset:63488
    ds_read_b64_tr_b16 v[190:191], v8 offset:64000
    s_waitcnt vmcnt(2) lgkmcnt(8)
    v_mfma_f32_32x32x16_bf16 v[64:79], a[116:119], v[168:171], v[64:79]
    v_mfma_f32_32x32x16_bf16 v[80:95], a[116:119], v[172:175], v[80:95]
    s_waitcnt vmcnt(1) lgkmcnt(4)
    v_mfma_f32_32x32x16_bf16 v[64:79], a[120:123], v[176:179], v[64:79]
    v_mfma_f32_32x32x16_bf16 v[80:95], a[120:123], v[180:183], v[80:95]
    s_waitcnt vmcnt(0) lgkmcnt(0)
    v_mfma_f32_32x32x16_bf16 v[64:79], a[124:127], v[184:187], v[64:79]
    v_mfma_f32_32x32x16_bf16 v[80:95], a[124:127], v[188:191], v[80:95]
    s_nop 11
    v_cvt_pk_bf16_f32 v129, v64, v80
    v_lshlrev_b32 v128, 16, v129
    v_and_b32 v129, 0xffff0000, v129
    s_mov_b32 s58, 0
    buffer_store_dword v128, v247, s[40:43], s58 offen nt
    buffer_store_dword v129, v247, s[40:43], s58 offen offset:128 nt
    v_cvt_pk_bf16_f32 v131, v65, v81
    v_lshlrev_b32 v130, 16, v131
    v_and_b32 v131, 0xffff0000, v131
    s_mov_b32 s58, 65536
    buffer_store_dword v130, v247, s[40:43], s58 offen nt
    buffer_store_dword v131, v247, s[40:43], s58 offen offset:128 nt
    v_cvt_pk_bf16_f32 v133, v66, v82
    v_lshlrev_b32_e64 v132, 16, v133
    v_and_b32 v133, 0xffff0000, v133
    s_mov_b32 s58, 4096
    buffer_store_dword v132, v247, s[40:43], s58 offen nt
    buffer_store_dword v133, v247, s[40:43], s58 offen offset:128 nt
    v_cvt_pk_bf16_f32 v135, v67, v83
    v_lshlrev_b32_e64 v134, 16, v135
    v_and_b32 v135, 0xffff0000, v135
    s_mov_b32 s58, 69632
    buffer_store_dword v134, v247, s[40:43], s58 offen nt
    buffer_store_dword v135, v247, s[40:43], s58 offen offset:128 nt
    v_cvt_pk_bf16_f32 v137, v68, v84
    v_lshlrev_b32_e64 v136, 16, v137
    v_and_b32 v137, 0xffff0000, v137
    s_mov_b32 s58, 8192
    buffer_store_dword v136, v247, s[40:43], s58 offen nt
    buffer_store_dword v137, v247, s[40:43], s58 offen offset:128 nt
    v_cvt_pk_bf16_f32 v139, v69, v85
    v_lshlrev_b32_e64 v138, 16, v139
    v_and_b32 v139, 0xffff0000, v139
    s_mov_b32 s58, 73728
    buffer_store_dword v138, v247, s[40:43], s58 offen nt
    buffer_store_dword v139, v247, s[40:43], s58 offen offset:128 nt
    v_cvt_pk_bf16_f32 v141, v70, v86
    v_lshlrev_b32_e64 v140, 16, v141
    v_and_b32 v141, 0xffff0000, v141
    s_mov_b32 s58, 12288
    buffer_store_dword v140, v247, s[40:43], s58 offen nt
    buffer_store_dword v141, v247, s[40:43], s58 offen offset:128 nt
    v_cvt_pk_bf16_f32 v143, v71, v87
    v_lshlrev_b32_e64 v142, 16, v143
    v_and_b32 v143, 0xffff0000, v143
    s_mov_b32 s58, 77824
    buffer_store_dword v142, v247, s[40:43], s58 offen nt
    buffer_store_dword v143, v247, s[40:43], s58 offen offset:128 nt
    v_cvt_pk_bf16_f32 v145, v72, v88
    v_lshlrev_b32_e64 v144, 16, v145
    v_and_b32 v145, 0xffff0000, v145
    s_mov_b32 s58, 16384
    buffer_store_dword v144, v247, s[40:43], s58 offen nt
    buffer_store_dword v145, v247, s[40:43], s58 offen offset:128 nt
    v_cvt_pk_bf16_f32 v147, v73, v89
    v_lshlrev_b32_e64 v146, 16, v147
    v_and_b32 v147, 0xffff0000, v147
    s_mov_b32 s58, 81920
    buffer_store_dword v146, v247, s[40:43], s58 offen nt
    buffer_store_dword v147, v247, s[40:43], s58 offen offset:128 nt
    v_cvt_pk_bf16_f32 v149, v74, v90
    v_lshlrev_b32_e64 v148, 16, v149
    v_and_b32 v149, 0xffff0000, v149
    s_mov_b32 s58, 20480
    buffer_store_dword v148, v247, s[40:43], s58 offen nt
    buffer_store_dword v149, v247, s[40:43], s58 offen offset:128 nt
    v_cvt_pk_bf16_f32 v151, v75, v91
    v_lshlrev_b32_e64 v150, 16, v151
    v_and_b32 v151, 0xffff0000, v151
    s_mov_b32 s58, 86016
    buffer_store_dword v150, v247, s[40:43], s58 offen nt
    buffer_store_dword v151, v247, s[40:43], s58 offen offset:128 nt
    v_cvt_pk_bf16_f32 v153, v76, v92
    v_lshlrev_b32_e64 v152, 16, v153
    v_and_b32 v153, 0xffff0000, v153
    s_mov_b32 s58, 24576
    buffer_store_dword v152, v247, s[40:43], s58 offen nt
    buffer_store_dword v153, v247, s[40:43], s58 offen offset:128 nt
    v_cvt_pk_bf16_f32 v155, v77, v93
    v_lshlrev_b32_e64 v154, 16, v155
    v_and_b32 v155, 0xffff0000, v155
    s_mov_b32 s58, 90112
    buffer_store_dword v154, v247, s[40:43], s58 offen nt
    buffer_store_dword v155, v247, s[40:43], s58 offen offset:128 nt
    v_cvt_pk_bf16_f32 v157, v78, v94
    v_lshlrev_b32_e64 v156, 16, v157
    v_and_b32 v157, 0xffff0000, v157
    s_mov_b32 s58, 28672
    buffer_store_dword v156, v247, s[40:43], s58 offen nt
    buffer_store_dword v157, v247, s[40:43], s58 offen offset:128 nt
    v_cvt_pk_bf16_f32 v159, v79, v95
    v_lshlrev_b32_e64 v158, 16, v159
    v_and_b32 v159, 0xffff0000, v159
    s_mov_b32 s58, 94208
    buffer_store_dword v158, v247, s[40:43], s58 offen nt
    buffer_store_dword v159, v247, s[40:43], s58 offen offset:128 nt
    s_add_u32 s48, s2, s20
    s_cmp_lg_u32 s48, 1
    s_cbranch_scc1 Ltag_9
    v_mov_b32 v2, 9502848
    v_mov_b32_e64 v3, s3
    s_mov_b64 exec, 1
    buffer_store_dword v3, v2, s[36:39], 0 offen sc1
    s_mov_b64 exec, -1
Ltag_9:
L_end:
    s_endpgm
Lpfo_4:
    s_mov_b32 s59, 262144
Lpf_2:
    buffer_load_dword v251, v249, s[64:67], s52 offen sc1
    s_waitcnt vmcnt(0)
    v_cmp_ne_u32 vcc, s3, v251
    s_cbranch_vccz Lpfd_3
    s_sub_u32 s59, s59, 1
    s_cmp_eq_u32 s59, 0
    s_cbranch_scc1 Lpfd_3
    s_sleep 1
    s_branch Lpf_2
Lk1:
    v_cmp_eq_u32 vcc, -1, v10
    s_cbranch_vccz Lk1r_0
    buffer_load_dword v10, v244, s[64:67], s8 offen offset:0 sc1
    buffer_load_dwordx4 v[96:99], v243, s[64:67], s4 offen offset:0 sc1
    buffer_load_dwordx4 v[100:103], v243, s[64:67], s4 offen offset:1024 sc1
    s_mov_b32 s85, 1
Lk1r_0:
    v_cmp_eq_u32 vcc, -1, v11
    s_cbranch_vccz Lk1r_1
    buffer_load_dword v11, v244, s[64:67], s8 offen offset:256 sc1
    buffer_load_dwordx4 v[104:107], v243, s[64:67], s4 offen offset:2048 sc1
    buffer_load_dwordx4 v[108:111], v243, s[64:67], s4 offen offset:3072 sc1
    s_mov_b32 s85, 1
Lk1r_1:
    v_cmp_eq_u32 vcc, -1, v12
    s_cbranch_vccz Lk1r_2
    buffer_load_dword v12, v244, s[64:67], s9 offen offset:0 sc1
    buffer_load_dwordx4 v[112:115], v243, s[64:67], s5 offen offset:0 sc1
    buffer_load_dwordx4 v[116:119], v243, s[64:67], s5 offen offset:1024 sc1
    s_mov_b32 s85, 1
Lk1r_2:
    v_cmp_eq_u32 vcc, -1, v13
    s_cbranch_vccz Lk1r_3
    buffer_load_dword v13, v244, s[64:67], s9 offen offset:256 sc1
    buffer_load_dwordx4 v[120:123], v243, s[64:67], s5 offen offset:2048 sc1
    buffer_load_dwordx4 v[124:127], v243, s[64:67], s5 offen offset:3072 sc1
    s_mov_b32 s85, 1
Lk1r_3:
    v_cmp_eq_u32 vcc, -1, v14
    s_cbranch_vccz Lk1r_4
    buffer_load_dword v14, v244, s[64:67], s10 offen offset:0 sc1
    buffer_load_dwordx4 v[128:131], v243, s[64:67], s6 offen offset:0 sc1
    buffer_load_dwordx4 v[132:135], v243, s[64:67], s6 offen offset:1024 sc1
    s_mov_b32 s85, 1
Lk1r_4:
    v_cmp_eq_u32 vcc, -1, v15
    s_cbranch_vccz Lk1r_5
    buffer_load_dword v15, v244, s[64:67], s10 offen offset:256 sc1
    buffer_load_dwordx4 v[136:139], v243, s[64:67], s6 offen offset:2048 sc1
    buffer_load_dwordx4 v[140:143], v243, s[64:67], s6 offen offset:3072 sc1
    s_mov_b32 s85, 1
Lk1r_5:
    v_cmp_eq_u32 vcc, -1, v16
    s_cbranch_vccz Lk1r_6
    buffer_load_dword v16, v244, s[64:67], s11 offen offset:0 sc1
    buffer_load_dwordx4 v[144:147], v243, s[64:67], s7 offen offset:0 sc1
    buffer_load_dwordx4 v[148:151], v243, s[64:67], s7 offen offset:1024 sc1
    s_mov_b32 s85, 1
Lk1r_6:
    v_cmp_eq_u32 vcc, -1, v17
    s_cbranch_vccz Lk1r_7
    buffer_load_dword v17, v244, s[64:67], s11 offen offset:256 sc1
    buffer_load_dwordx4 v[152:155], v243, s[64:67], s7 offen offset:2048 sc1
    buffer_load_dwordx4 v[156:159], v243, s[64:67], s7 offen offset:3072 sc1
    s_mov_b32 s85, 1
Lk1r_7:
    s_branch Lk1d
Lk2:
    s_waitcnt vmcnt(0)
    s_mov_b32 s85, 0
    v_cmp_eq_u32 vcc, -1, v10
    s_cbranch_vccz Lk2r_0
    buffer_load_dword v10, v244, s[64:67], s8 offen offset:0 sc1
    buffer_load_dwordx4 v[96:99], v243, s[64:67], s4 offen offset:0 sc1
    buffer_load_dwordx4 v[100:103], v243, s[64:67], s4 offen offset:1024 sc1
    s_mov_b32 s85, 1
Lk2r_0:
    v_cmp_eq_u32 vcc, -1, v11
    s_cbranch_vccz Lk2r_1
    buffer_load_dword v11, v244, s[64:67], s8 offen offset:256 sc1
    buffer_load_dwordx4 v[104:107], v243, s[64:67], s4 offen offset:2048 sc1
    buffer_load_dwordx4 v[108:111], v243, s[64:67], s4 offen offset:3072 sc1
    s_mov_b32 s85, 1
Lk2r_1:
    v_cmp_eq_u32 vcc, -1, v12
    s_cbranch_vccz Lk2r_2
    buffer_load_dword v12, v244, s[64:67], s9 offen offset:0 sc1
    buffer_load_dwordx4 v[112:115], v243, s[64:67], s5 offen offset:0 sc1
    buffer_load_dwordx4 v[116:119], v243, s[64:67], s5 offen offset:1024 sc1
    s_mov_b32 s85, 1
Lk2r_2:
    v_cmp_eq_u32 vcc, -1, v13
    s_cbranch_vccz Lk2r_3
    buffer_load_dword v13, v244, s[64:67], s9 offen offset:256 sc1
    buffer_load_dwordx4 v[120:123], v243, s[64:67], s5 offen offset:2048 sc1
    buffer_load_dwordx4 v[124:127], v243, s[64:67], s5 offen offset:3072 sc1
    s_mov_b32 s85, 1
Lk2r_3:
    v_cmp_eq_u32 vcc, -1, v14
    s_cbranch_vccz Lk2r_4
    buffer_load_dword v14, v244, s[64:67], s10 offen offset:0 sc1
    buffer_load_dwordx4 v[128:131], v243, s[64:67], s6 offen offset:0 sc1
    buffer_load_dwordx4 v[132:135], v243, s[64:67], s6 offen offset:1024 sc1
    s_mov_b32 s85, 1
Lk2r_4:
    v_cmp_eq_u32 vcc, -1, v15
    s_cbranch_vccz Lk2r_5
    buffer_load_dword v15, v244, s[64:67], s10 offen offset:256 sc1
    buffer_load_dwordx4 v[136:139], v243, s[64:67], s6 offen offset:2048 sc1
    buffer_load_dwordx4 v[140:143], v243, s[64:67], s6 offen offset:3072 sc1
    s_mov_b32 s85, 1
Lk2r_5:
    v_cmp_eq_u32 vcc, -1, v16
    s_cbranch_vccz Lk2r_6
    buffer_load_dword v16, v244, s[64:67], s11 offen offset:0 sc1
    buffer_load_dwordx4 v[144:147], v243, s[64:67], s7 offen offset:0 sc1
    buffer_load_dwordx4 v[148:151], v243, s[64:67], s7 offen offset:1024 sc1
    s_mov_b32 s85, 1
Lk2r_6:
    v_cmp_eq_u32 vcc, -1, v17
    s_cbranch_vccz Lk2r_7
    buffer_load_dword v17, v244, s[64:67], s11 offen offset:256 sc1
    buffer_load_dwordx4 v[152:155], v243, s[64:67], s7 offen offset:2048 sc1
    buffer_load_dwordx4 v[156:159], v243, s[64:67], s7 offen offset:3072 sc1
    s_mov_b32 s85, 1
Lk2r_7:
    s_sub_u32 s59, s59, 1
    s_cmp_eq_u32 s85, 0
    s_cbranch_scc1 Lk2d
    s_cmp_lg_u32 s59, 0
    s_cbranch_scc1 Lk2
    s_waitcnt vmcnt(0)
    s_branch Lk2d
Lk3:
    v_max3_u32 v18, v10, v11, v12
    v_max3_u32 v19, v13, v14, v15
    v_max3_u32 v18, v18, v16, v17
    v_max_u32_e64 v18, v18, v19
    v_max3_u32 v18, v18, v96, v97
    v_max3_u32 v18, v18, v98, v99
    v_max3_u32 v18, v18, v100, v101
    v_max3_u32 v18, v18, v102, v103
    v_max3_u32 v18, v18, v104, v105
    v_max3_u32 v18, v18, v106, v107
    v_max3_u32 v18, v18, v108, v109
    v_max3_u32 v18, v18, v110, v111
    v_max3_u32 v18, v18, v112, v113
    v_max3_u32 v18, v18, v114, v115
    v_max3_u32 v18, v18, v116, v117
    v_max3_u32 v18, v18, v118, v119
    v_max3_u32 v18, v18, v120, v121
    v_max3_u32 v18, v18, v122, v123
    v_max3_u32 v18, v18, v124, v125
    v_max3_u32 v18, v18, v126, v127
    v_max3_u32 v18, v18, v128, v129
    v_max3_u32 v18, v18, v130, v131
    v_max3_u32 v18, v18, v132, v133
    v_max3_u32 v18, v18, v134, v135
    v_max3_u32 v18, v18, v136, v137
    v_max3_u32 v18, v18, v138, v139
    v_max3_u32 v18, v18, v140, v141
    v_max3_u32 v18, v18, v142, v143
    v_max3_u32 v18, v18, v144, v145
    v_max3_u32 v18, v18, v146, v147
    v_max3_u32 v18, v18, v148, v149
    v_max3_u32 v18, v18, v150, v151
    v_max3_u32 v18, v18, v152, v153
    v_max3_u32 v18, v18, v154, v155
    v_max3_u32 v18, v18, v156, v157
    v_max3_u32 v18, v18, v158, v159
    v_cmp_eq_u32 vcc, -1, v18
    s_cbranch_vccz Lk3d
    s_cmp_eq_u32 s59, 0
    s_cbranch_scc1 Lk3d
    s_sub_u32 s59, s59, 1
    buffer_load_dword v10, v244, s[64:67], s8 offen offset:0 sc1
    buffer_load_dword v11, v244, s[64:67], s8 offen offset:256 sc1
    buffer_load_dword v12, v244, s[64:67], s9 offen offset:0 sc1
    buffer_load_dword v13, v244, s[64:67], s9 offen offset:256 sc1
    buffer_load_dword v14, v244, s[64:67], s10 offen offset:0 sc1
    buffer_load_dword v15, v244, s[64:67], s10 offen offset:256 sc1
    buffer_load_dword v16, v244, s[64:67], s11 offen offset:0 sc1
    buffer_load_dword v17, v244, s[64:67], s11 offen offset:256 sc1
    buffer_load_dwordx4 v[96:99], v243, s[64:67], s4 offen offset:0 sc1
    buffer_load_dwordx4 v[100:103], v243, s[64:67], s4 offen offset:1024 sc1
    buffer_load_dwordx4 v[104:107], v243, s[64:67], s4 offen offset:2048 sc1
    buffer_load_dwordx4 v[108:111], v243, s[64:67], s4 offen offset:3072 sc1
    buffer_load_dwordx4 v[112:115], v243, s[64:67], s5 offen offset:0 sc1
    buffer_load_dwordx4 v[116:119], v243, s[64:67], s5 offen offset:1024 sc1
    buffer_load_dwordx4 v[120:123], v243, s[64:67], s5 offen offset:2048 sc1
    buffer_load_dwordx4 v[124:127], v243, s[64:67], s5 offen offset:3072 sc1
    buffer_load_dwordx4 v[128:131], v243, s[64:67], s6 offen offset:0 sc1
    buffer_load_dwordx4 v[132:135], v243, s[64:67], s6 offen offset:1024 sc1
    buffer_load_dwordx4 v[136:139], v243, s[64:67], s6 offen offset:2048 sc1
    buffer_load_dwordx4 v[140:143], v243, s[64:67], s6 offen offset:3072 sc1
    buffer_load_dwordx4 v[144:147], v243, s[64:67], s7 offen offset:0 sc1
    buffer_load_dwordx4 v[148:151], v243, s[64:67], s7 offen offset:1024 sc1
    buffer_load_dwordx4 v[152:155], v243, s[64:67], s7 offen offset:2048 sc1
    buffer_load_dwordx4 v[156:159], v243, s[64:67], s7 offen offset:3072 sc1
    s_waitcnt vmcnt(0)
    v_add_f32 v18, v10, v11
    v_add_f32 v18, v18, v12
    v_add_f32 v18, v18, v13
    v_add_f32 v18, v18, v14
    v_add_f32 v18, v18, v15
    v_add_f32 v18, v18, v16
    v_add_f32 v18, v18, v17
    v_mov_b32 v19, v18
    s_nop 1
    v_permlane32_swap_b32 v18, v19
    v_add_f32 v18, v18, v19
    v_cvt_pk_bf16_f32 v20, v18, v18
    v_mfma_f32_32x32x16_bf16 v[224:239], v[96:99], v[4:7], 0
    v_mfma_f32_32x32x16_bf16 v[224:239], v[100:103], v[4:7], v[224:239]
    v_mfma_f32_32x32x16_bf16 v[224:239], v[104:107], v[4:7], v[224:239]
    v_mfma_f32_32x32x16_bf16 v[224:239], v[108:111], v[4:7], v[224:239]
    v_mfma_f32_32x32x16_bf16 v[224:239], v[112:115], v[4:7], v[224:239]
    v_mfma_f32_32x32x16_bf16 v[224:239], v[116:119], v[4:7], v[224:239]
    v_mfma_f32_32x32x16_bf16 v[224:239], v[120:123], v[4:7], v[224:239]
    v_mfma_f32_32x32x16_bf16 v[224:239], v[124:127], v[4:7], v[224:239]
    v_mfma_f32_32x32x16_bf16 v[224:239], v[128:131], v[4:7], v[224:239]
    v_mfma_f32_32x32x16_bf16 v[224:239], v[132:135], v[4:7], v[224:239]
    v_mfma_f32_32x32x16_bf16 v[224:239], v[136:139], v[4:7], v[224:239]
    v_mfma_f32_32x32x16_bf16 v[224:239], v[140:143], v[4:7], v[224:239]
    v_mfma_f32_32x32x16_bf16 v[224:239], v[144:147], v[4:7], v[224:239]
    v_mfma_f32_32x32x16_bf16 v[224:239], v[148:151], v[4:7], v[224:239]
    v_mfma_f32_32x32x16_bf16 v[224:239], v[152:155], v[4:7], v[224:239]
    v_mfma_f32_32x32x16_bf16 v[224:239], v[156:159], v[4:7], v[224:239]
    v_mfma_f32_32x32x16_bf16 v[224:239], v[20:23], v[252:255], v[224:239]
    s_nop 11
    v_cvt_pk_bf16_f32 v72, v224, v225
    v_cvt_pk_bf16_f32 v73, v226, v227
    v_cvt_pk_bf16_f32 v74, v228, v229
    v_cvt_pk_bf16_f32 v75, v230, v231
    v_cvt_pk_bf16_f32 v76, v232, v233
    v_cvt_pk_bf16_f32 v77, v234, v235
    v_cvt_pk_bf16_f32 v78, v236, v237
    v_cvt_pk_bf16_f32 v79, v238, v239
    v_mfma_f32_32x32x16_bf16 v[224:239], v[72:75], v[208:211], 0
    s_nop 0
    v_mfma_f32_32x32x16_bf16 v[224:239], v[76:79], v[212:215], v[224:239]
    s_nop 11
    v_add_f32 v232, 0x358637bd, v232
    s_branch Lk3
L_role2:
    s_load_dwordx4 s[84:87], s[0:1], 8
    s_load_dwordx4 s[88:91], s[0:1], 56
    s_load_dwordx2 s[92:93], s[0:1], 40
    s_load_dwordx2 s[96:97], s[0:1], 48
    s_load_dwordx2 s[40:41], s[0:1], 104
    v_and_b32 v9, 31, v1
    s_and_b32 s63, s20, 1
    s_lshl_b32 s63, s63, 5
    s_lshl_b32 s52, s51, 6
    s_add_u32 s52, s52, s63
    v_add_u32 v41, s52, v9
    v_lshlrev_b32 v41, 1, v41
    s_add_u32 s56, s55, 2
    s_and_b32 s56, s56, 7
    s_lshl_b32 s6, s56, 7
    s_add_u32 s56, s55, 3
    s_and_b32 s56, s56, 7
    s_lshl_b32 s7, s56, 7
    s_add_u32 s56, s55, 4
    s_and_b32 s56, s56, 7
    s_lshl_b32 s8, s56, 7
    s_add_u32 s56, s55, 5
    s_and_b32 s56, s56, 7
    s_lshl_b32 s9, s56, 7
    s_add_u32 s56, s55, 6
    s_and_b32 s56, s56, 7
    s_lshl_b32 s10, s56, 7
    s_add_u32 s56, s55, 7
    s_and_b32 s56, s56, 7
    s_lshl_b32 s11, s56, 7
    s_mov_b32 s38, 268435456
    s_mov_b32 s39, 0x20000
    s_mov_b32 s42, 8388608
    s_mov_b32 s43, 0x20000
    s_mov_b32 s94, 524288
    s_mov_b32 s95, 0x20000
    s_mov_b32 s98, 524288
    s_mov_b32 s99, 0x20000
    s_lshl_b32 s48, s51, 14
    s_add_u32 s48, s48, 6291456
    s_add_u32 s64, s36, s48
    s_addc_u32 s65, s37, 0
    s_mov_b32 s66, 16384
    s_mov_b32 s67, 0x20000
    v_lshrrev_b32 v8, 5, v1
    v_bfe_u32 v4, v1, 1, 3
    v_xor_b32_e64 v3, v8, v4
    v_lshlrev_b32 v3, 4, v3
    v_lshl_add_u32 v3, v9, 7, v3
    s_lshr_b32 s62, s20, 1
    s_lshl_b32 s48, s62, 13
    s_lshl_b32 s49, s63, 7
    s_add_u32 s49, s49, 16384
    v_xor_b32 v4, 0, v3
    v_add_u32 v16, s48, v4
    v_add_u32 v20, s49, v4
    v_xor_b32 v4, 32, v3
    v_add_u32 v17, s48, v4
    v_add_u32 v21, s49, v4
    v_xor_b32 v4, 64, v3
    v_add_u32 v18, s48, v4
    v_add_u32 v22, s49, v4
    v_xor_b32 v4, 96, v3
    v_add_u32 v19, s48, v4
    v_add_u32 v23, s49, v4
    v_add_u32 v2, s63, v9
    v_lshlrev_b32 v3, 3, v2
    v_add_u32 v185, 65536, v3
    v_lshlrev_b32 v4, 9, v8
    s_lshl_b32 s48, s62, 10
    v_add3_u32 v184, v4, v185, s48
    s_sub_u32 s54, 15, s50
    s_lshl_b32 s54, s54, 10
    v_lshlrev_b32 v186, 4, v2
    v_lshlrev_b32 v189, 4, v1
    v_and_b32 v190, 15, v1
    v_mul_u32_u24 v190, 4, v190
    v_lshlrev_b32 v4, 13, v8
    v_add3_u32 v4, v4, v186, s54
    v_add_u32 v198, 1024, v4
    v_add_u32 v199, 4096, v198
    s_lshl_b32 s48, s20, 13
    s_add_u32 s48, s48, 65536
    v_lshlrev_b32 v3, 1, v8
    v_bfe_u32 v4, v1, 1, 2
    v_xor_b32 v3, v3, v4
    v_lshlrev_b32 v3, 4, v3
    v_lshl_add_u32 v3, v9, 6, v3
    v_add_u32_e64 v187, s48, v3
    v_bfe_u32 v4, v1, 2, 2
    v_lshl_add_u32 v3, v8, 3, v4
    v_lshlrev_b32 v3, 6, v3
    v_bfe_u32 v5, v1, 4, 1
    v_lshlrev_b32 v5, 1, v5
    v_bfe_u32 v6, v1, 1, 1
    v_add_u32 v5, v5, v6
    v_lshrrev_b32 v4, 1, v4
    v_xor_b32 v5, v5, v4
    v_lshl_add_u32 v3, v5, 4, v3
    v_and_b32 v6, 1, v1
    v_lshl_add_u32 v3, v6, 3, v3
    v_add_u32 v188, s48, v3
    s_lshl_b32 s48, s50, 2
    s_add_u32 s48, s48, s20
    s_lshl_b32 s68, s48, 16
    s_add_u32 s68, s68, 0
    s_mul_i32 s12, s48, 64
    s_add_u32 s12, s12, 8388608
    s_and_b32 s48, s48, 0xfffe
    s_mul_i32 s13, s48, 64
    s_add_u32 s13, s13, 8388608
    s_add_u32 s14, s13, 64
    s_lshl_b32 s48, s48, 6
    s_lshl_b32 s49, s51, 2
    s_add_u32 s48, s48, s49
    s_lshr_b32 s49, s63, 4
    s_add_u32 s48, s48, s49
    s_lshl_b32 s15, s48, 10
    s_add_u32 s15, s15, 0
    s_lshl_b32 s48, s51, 1
    s_lshr_b32 s49, s63, 5
    s_add_u32 s48, s48, s49
    s_mul_i32 s16, s48, 4
    v_lshl_add_u32 v2, v8, 2, s46
    s_lshl_b32 s49, s51, 7
    v_lshl_add_u32 v193, v9, 2, s49
    v_lshl_add_u32 v191, v2, 10, v193
    v_lshlrev_b32 v3, 1, v193
    v_lshl_add_u32 v192, v2, 12, v3
    v_and_b32 v3, 15, v1
    v_xor_b32 v3, v3, v8
    v_lshlrev_b32 v3, 4, v3
    v_lshl_add_u32 v3, v9, 10, v3
    v_add_u32 v3, 98304, v3
    v_xor_b32_e64 v200, 0, v3
    v_xor_b32 v201, 32, v3
    v_xor_b32 v202, 64, v3
    v_xor_b32 v203, 96, v3
    v_xor_b32 v204, 128, v3
    v_xor_b32 v205, 160, v3
    v_xor_b32 v206, 192, v3
    v_xor_b32 v207, 224, v3
    s_lshl_b32 s69, s51, 6
    s_lshl_b32 s48, s20, 4
    s_add_u32 s69, s69, s48
    s_lshl_b32 s69, s69, 10
    s_lshl_b32 s44, s20, 13
    s_and_b32 s45, s20, 1
    s_lshl_b32 s45, s45, 7
    v_lshlrev_b32 v195, 7, v1
    v_and_b32 v195, 0xfff, v195
    s_lshl_b32 s48, s51, 6
    s_and_b32 s49, s50, 3
    s_lshl_b32 s49, s49, 4
    s_add_u32 s48, s48, s49
    s_lshl_b32 s49, s20, 2
    s_add_u32 s48, s48, s49
    s_lshl_b32 s48, s48, 10
    v_add_u32 v195, s48, v195
    s_waitcnt lgkmcnt(0)
    s_add_u32 s52, s36, 9502720
    s_addc_u32 s53, s37, 0
    s_load_dword s3, s[52:53], 0
    global_load_ushort v44, v41, s[84:85]
    global_load_ushort v45, v41, s[86:87]
    global_load_ushort v46, v41, s[88:89]
    buffer_load_dword v40, v190, s[36:39], s12 offen sc1
    s_add_u32 m0, s60, 35840
    s_nop 0
    buffer_load_dwordx4 v13, s[24:27], s5 offen lds
    s_add_u32 m0, s61, 49152
    s_nop 0
    buffer_load_dwordx4 v14, s[28:31], s5 offen lds
    s_add_u32 m0, s61, 50176
    s_nop 0
    buffer_load_dwordx4 v15, s[28:31], s5 offen lds
    s_add_u32 m0, s61, 57344
    s_nop 0
    buffer_load_dwordx4 v14, s[32:35], s5 offen lds
    s_add_u32 m0, s61, 58368
    s_nop 0
    buffer_load_dwordx4 v15, s[32:35], s5 offen lds
    s_waitcnt lgkmcnt(0)
    s_add_u32 s3, s3, 1
    s_max_u32 s3, s3, 1
    v_mov_b32 v194, s3
    v_lshlrev_b32 v2, 3, v8
    v_add_u32 v3, 1, v2
    v_cmp_ge_u32 vcc, s50, v3
    s_nop 1
    v_cndmask_b32 v176, 0, v194, vcc
    v_add_u32 v3, 2, v2
    v_cmp_ge_u32 vcc, s50, v3
    s_nop 1
    v_cndmask_b32 v177, 0, v194, vcc
    v_add_u32 v3, 3, v2
    v_cmp_ge_u32 vcc, s50, v3
    s_nop 1
    v_cndmask_b32 v178, 0, v194, vcc
    v_add_u32 v3, 4, v2
    v_cmp_ge_u32 vcc, s50, v3
    s_nop 1
    v_cndmask_b32 v179, 0, v194, vcc
    v_add_u32 v3, 5, v2
    v_cmp_ge_u32 vcc, s50, v3
    s_nop 1
    v_cndmask_b32 v180, 0, v194, vcc
    v_add_u32 v3, 6, v2
    v_cmp_ge_u32 vcc, s50, v3
    s_nop 1
    v_cndmask_b32 v181, 0, v194, vcc
    v_add_u32 v3, 7, v2
    v_cmp_ge_u32 vcc, s50, v3
    s_nop 1
    v_cndmask_b32 v182, 0, v194, vcc
    v_add_u32 v3, 8, v2
    v_cmp_ge_u32 vcc, s50, v3
    s_nop 1
    v_cndmask_b32 v183, 0, v194, vcc
    s_bitcmp1_b32 s50, 8
    s_cselect_b32 s48, s96, s92
    s_cselect_b32 s49, s97, s93
    s_cselect_b32 s96, s92, s96
    s_cselect_b32 s97, s93, s97
    s_mov_b32 s92, s48
    s_mov_b32 s93, s49
    s_cselect_b32 s17, 32768, 0
    s_getreg_b32 s23, hwreg(HW_REG_XCC_ID)
    s_and_b32 s23, s23, 7
    s_lshl_b32 s52, s3, 3
    s_or_b32 s23, s23, s52
    s_lshl_b32 s47, s50, 10
    s_add_u32 s47, s47, 9437184
    s_lshl_b32 s52, s51, 7
    s_cmp_eq_u32 s20, 0
    s_cselect_b32 s52, s52, 0x7ff00000
    v_mov_b32 v42, s52
    v_mov_b32 v43, s23
    s_waitcnt vmcnt(12) lgkmcnt(0)
    s_barrier
    ds_read_b128 v[128:131], v16
    ds_read_b128 v[136:139], v20
    ds_read_b128 v[140:143], v20 offset:8192
    ds_read_b128 v[132:135], v16 offset:4096
    ds_read_b128 v[144:147], v17
    ds_read_b128 v[152:155], v21
    ds_read_b128 v[156:159], v21 offset:8192
    ds_read_b128 v[148:151], v17 offset:4096
    s_add_u32 m0, s60, 65536
    s_nop 0
    buffer_load_dwordx4 v10, s[24:27], s6 offen lds
    s_add_u32 m0, s60, 66560
    s_nop 0
    buffer_load_dwordx4 v11, s[24:27], s6 offen lds
    s_add_u32 m0, s60, 67584
    s_nop 0
    buffer_load_dwordx4 v12, s[24:27], s6 offen lds
    s_add_u32 m0, s60, 68608
    s_nop 0
    buffer_load_dwordx4 v13, s[24:27], s6 offen lds
    s_add_u32 m0, s61, 81920
    s_nop 0
    buffer_load_dwordx4 v14, s[28:31], s6 offen lds
    s_add_u32 m0, s61, 82944
    s_nop 0
    buffer_load_dwordx4 v15, s[28:31], s6 offen lds
    s_add_u32 m0, s61, 90112
    s_nop 0
    buffer_load_dwordx4 v14, s[32:35], s6 offen lds
    s_add_u32 m0, s61, 91136
    s_nop 0
    buffer_load_dwordx4 v15, s[32:35], s6 offen lds
    s_waitcnt lgkmcnt(4)
    v_mfma_f32_32x32x16_bf16 v[64:79], v[128:131], v[136:139], 0
    ds_read_b128 v[160:163], v18
    v_mfma_f32_32x32x16_bf16 v[96:111], v[128:131], v[140:143], 0
    ds_read_b128 v[168:171], v22
    s_add_u32 m0, s60, 98304
    s_nop 0
    buffer_load_dwordx4 v10, s[24:27], s7 offen lds
    v_mfma_f32_32x32x16_bf16 v[80:95], v[132:135], v[136:139], 0
    ds_read_b128 v[172:175], v22 offset:8192
    v_mfma_f32_32x32x16_bf16 v[112:127], v[132:135], v[140:143], 0
    ds_read_b128 v[164:167], v18 offset:4096
    s_add_u32 m0, s60, 99328
    s_nop 0
    buffer_load_dwordx4 v11, s[24:27], s7 offen lds
    s_waitcnt lgkmcnt(4)
    v_mfma_f32_32x32x16_bf16 v[64:79], v[144:147], v[152:155], v[64:79]
    ds_read_b128 v[128:131], v19
    v_mfma_f32_32x32x16_bf16 v[96:111], v[144:147], v[156:159], v[96:111]
    ds_read_b128 v[136:139], v23
    s_add_u32 m0, s60, 100352
    s_nop 0
    buffer_load_dwordx4 v12, s[24:27], s7 offen lds
    v_mfma_f32_32x32x16_bf16 v[80:95], v[148:151], v[152:155], v[80:95]
    ds_read_b128 v[140:143], v23 offset:8192
    v_mfma_f32_32x32x16_bf16 v[112:127], v[148:151], v[156:159], v[112:127]
    ds_read_b128 v[132:135], v19 offset:4096
    s_add_u32 m0, s60, 101376
    s_nop 0
    buffer_load_dwordx4 v13, s[24:27], s7 offen lds
    s_waitcnt lgkmcnt(4)
    v_mfma_f32_32x32x16_bf16 v[64:79], v[160:163], v[168:171], v[64:79]
    s_waitcnt vmcnt(12)
    s_barrier
    v_add_u32 v16, 32768, v16
    v_add_u32 v20, 32768, v20
    s_add_u32 m0, s61, 114688
    s_nop 0
    buffer_load_dwordx4 v14, s[28:31], s7 offen lds
    v_mov_b32 v7, s62
    v_lshlrev_b32 v44, 16, v44
    v_lshlrev_b32_e64 v45, 16, v45
    v_mfma_f32_32x32x16_bf16 v[96:111], v[160:163], v[172:175], v[96:111]
    ds_read_b128 v[144:147], v16
    ds_read_b128 v[152:155], v20
    v_lshlrev_b32_e64 v46, 16, v46
    v_mul_f32 v46, 1069066811, v46
    v_mfma_f32_32x32x16_bf16 v[80:95], v[164:167], v[168:171], v[80:95]
    ds_read_b128 v[156:159], v20 offset:8192
    ds_read_b128 v[148:151], v16 offset:4096
    s_add_u32 m0, s61, 115712
    s_nop 0
    buffer_load_dwordx4 v15, s[28:31], s7 offen lds
    v_exp_f32_e64 v46, v46
    s_nop 0
    v_cvt_pk_bf16_f32 v46, v46, v46
    v_mfma_f32_32x32x16_bf16 v[112:127], v[164:167], v[172:175], v[112:127]
    v_lshlrev_b32_e64 v46, 16, v46
    v_mul_f32 v47, v46, v44
    s_waitcnt lgkmcnt(4)
    v_mfma_f32_32x32x16_bf16 v[64:79], v[128:131], v[136:139], v[64:79]
    v_add_u32 v17, 32768, v17
    v_add_u32 v21, 32768, v21
    s_add_u32 m0, s61, 122880
    s_nop 0
    buffer_load_dwordx4 v14, s[32:35], s7 offen lds
    v_mul_f32 v48, v46, v45
    v_mul_f32 v47, 1069066811, v47
    v_exp_f32_e64 v47, v47
    v_mfma_f32_32x32x16_bf16 v[96:111], v[128:131], v[140:143], v[96:111]
    ds_read_b128 v[160:163], v17
    ds_read_b128 v[168:171], v21
    v_mul_f32 v48, 1042479491, v48
    v_rndne_f32 v49, v48
    v_mfma_f32_32x32x16_bf16 v[80:95], v[132:135], v[136:139], v[80:95]
    ds_read_b128 v[172:175], v21 offset:8192
    ds_read_b128 v[164:167], v17 offset:4096
    s_add_u32 m0, s61, 123904
    s_nop 0
    buffer_load_dwordx4 v15, s[32:35], s7 offen lds
    v_sub_f32 v48, v48, v49
    v_cos_f32 v49, v48
    v_mfma_f32_32x32x16_bf16 v[112:127], v[132:135], v[140:143], v[112:127]
    s_add_u32 m0, s60, 131072
    s_nop 0
    buffer_load_dwordx4 v10, s[24:27], s8 offen lds
    v_sin_f32 v50, v48
    s_waitcnt lgkmcnt(4)
    v_mfma_f32_32x32x16_bf16 v[64:79], v[144:147], v[152:155], v[64:79]
    v_add_u32 v18, 32768, v18
    v_add_u32 v22, 32768, v22
    v_mul_f32_e64 v24, v47, v49
    v_mul_f32 v25, v47, v50
    v_mul_f32 v47, v44, v44
    v_mfma_f32_32x32x16_bf16 v[96:111], v[144:147], v[156:159], v[96:111]
    ds_read_b128 v[128:131], v18
    ds_read_b128 v[136:139], v22
    s_add_u32 m0, s60, 132096
    s_nop 0
    buffer_load_dwordx4 v11, s[24:27], s8 offen lds
    v_fma_f32 v47, v45, v45, v47
    v_rcp_f32 v47, v47
    v_mfma_f32_32x32x16_bf16 v[80:95], v[148:151], v[152:155], v[80:95]
    ds_read_b128 v[140:143], v22 offset:8192
    ds_read_b128 v[132:135], v18 offset:4096
    v_add_f32_e64 v48, -1.0, v24
    v_mul_f32 v49, v48, v44
    v_mfma_f32_32x32x16_bf16 v[112:127], v[148:151], v[156:159], v[112:127]
    s_add_u32 m0, s60, 133120
    s_nop 0
    buffer_load_dwordx4 v12, s[24:27], s8 offen lds
    v_fma_f32 v49, v25, v45, v49
    v_mul_f32 v50, v25, v44
    s_waitcnt lgkmcnt(4)
    v_mfma_f32_32x32x16_bf16 v[64:79], v[160:163], v[168:171], v[64:79]
    v_add_u32 v19, 32768, v19
    v_add_u32 v23, 32768, v23
    v_fma_f32 v50, -v48, v45, v50
    v_add_f32 v47, v47, v47
    v_mul_f32 v26, v49, v47
    v_mfma_f32_32x32x16_bf16 v[96:111], v[160:163], v[172:175], v[96:111]
    ds_read_b128 v[144:147], v19
    ds_read_b128 v[152:155], v23
    s_add_u32 m0, s60, 134144
    s_nop 0
    buffer_load_dwordx4 v13, s[24:27], s8 offen lds
    v_mul_f32 v27, v50, v47
    v_mul_f32 v44, v24, v24
    v_mul_f32 v45, v24, v25
    v_mfma_f32_32x32x16_bf16 v[80:95], v[164:167], v[168:171], v[80:95]
    ds_read_b128 v[156:159], v23 offset:8192
    ds_read_b128 v[148:151], v19 offset:4096
    v_fma_f32 v44, -v25, v25, v44
    v_fma_f32 v45, v25, v24, v45
    v_mfma_f32_32x32x16_bf16 v[112:127], v[164:167], v[172:175], v[112:127]
    s_add_u32 m0, s61, 147456
    s_nop 0
    buffer_load_dwordx4 v14, s[28:31], s8 offen lds
    v_mul_f32 v46, v44, v44
    v_mul_f32 v47, v44, v45
    v_fma_f32 v46, -v45, v45, v46
    s_waitcnt lgkmcnt(4)
    v_mfma_f32_32x32x16_bf16 v[64:79], v[128:131], v[136:139], v[64:79]
    s_waitcnt vmcnt(13)
    s_barrier
    v_add_u32 v16, 32768, v16
    v_add_u32 v20, 32768, v20
    s_add_u32 m0, s61, 148480
    s_nop 0
    buffer_load_dwordx4 v15, s[28:31], s8 offen lds
    v_fma_f32 v47, v45, v44, v47
    v_mul_f32 v44, v46, v46
    v_mfma_f32_32x32x16_bf16 v[96:111], v[128:131], v[140:143], v[96:111]
    ds_read_b128 v[160:163], v16
    ds_read_b128 v[168:171], v20
    v_mul_f32_e64 v45, v46, v47
    v_fma_f32 v44, -v47, v47, v44
    v_fma_f32 v45, v47, v46, v45
    v_mfma_f32_32x32x16_bf16 v[80:95], v[132:135], v[136:139], v[80:95]
    ds_read_b128 v[172:175], v20 offset:8192
    ds_read_b128 v[164:167], v16 offset:4096
    s_add_u32 m0, s61, 155648
    s_nop 0
    buffer_load_dwordx4 v14, s[32:35], s8 offen lds
    v_mul_f32 v28, v44, v44
    v_mul_f32_e64 v29, v44, v45
    v_mfma_f32_32x32x16_bf16 v[112:127], v[132:135], v[140:143], v[112:127]
    v_fma_f32 v28, -v45, v45, v28
    v_fma_f32 v29, v45, v44, v29
    v_mul_f32 v30, v28, v28
    s_waitcnt lgkmcnt(4)
    v_mfma_f32_32x32x16_bf16 v[64:79], v[144:147], v[152:155], v[64:79]
    v_add_u32 v17, 32768, v17
    v_add_u32 v21, 32768, v21
    s_add_u32 m0, s61, 156672
    s_nop 0
    buffer_load_dwordx4 v15, s[32:35], s8 offen lds
    v_mul_f32 v31, v28, v29
    v_fma_f32 v30, -v29, v29, v30
    v_mfma_f32_32x32x16_bf16 v[96:111], v[144:147], v[156:159], v[96:111]
    ds_read_b128 v[128:131], v17
    ds_read_b128 v[136:139], v21
    v_fma_f32 v31, v29, v28, v31
    v_mul_f32 v48, v30, v30
    v_mul_f32 v49, v30, v31
    v_mfma_f32_32x32x16_bf16 v[80:95], v[148:151], v[152:155], v[80:95]
    ds_read_b128 v[140:143], v21 offset:8192
    ds_read_b128 v[132:135], v17 offset:4096
    s_add_u32 m0, s60, 0
    s_nop 0
    buffer_load_dwordx4 v10, s[24:27], s9 offen lds
    v_fma_f32 v48, -v31, v31, v48
    v_fma_f32 v49, v31, v30, v49
    v_mul_f32 v32, v48, v48
    v_mfma_f32_32x32x16_bf16 v[112:127], v[148:151], v[156:159], v[112:127]
    s_add_u32 m0, s60, 1024
    s_nop 0
    buffer_load_dwordx4 v11, s[24:27], s9 offen lds
    v_mul_f32 v33, v48, v49
    v_fma_f32 v32, -v49, v49, v32
    s_waitcnt lgkmcnt(4)
    v_mfma_f32_32x32x16_bf16 v[64:79], v[160:163], v[168:171], v[64:79]
    v_add_u32 v18, 32768, v18
    v_add_u32 v22, 32768, v22
    v_fma_f32 v33, v49, v48, v33
    v_mul_f32_e64 v44, v32, v32
    v_mul_f32 v45, v32, v33
    v_mfma_f32_32x32x16_bf16 v[96:111], v[160:163], v[172:175], v[96:111]
    ds_read_b128 v[144:147], v18
    ds_read_b128 v[152:155], v22
    s_add_u32 m0, s60, 2048
    s_nop 0
    buffer_load_dwordx4 v12, s[24:27], s9 offen lds
    v_fma_f32 v44, -v33, v33, v44
    v_fma_f32 v45, v33, v32, v45
    v_mfma_f32_32x32x16_bf16 v[80:95], v[164:167], v[168:171], v[80:95]
    ds_read_b128 v[156:159], v22 offset:8192
    ds_read_b128 v[148:151], v18 offset:4096
    v_mul_f32 v46, v44, v44
    v_mul_f32 v47, v44, v45
    v_fma_f32 v46, -v45, v45, v46
    v_mfma_f32_32x32x16_bf16 v[112:127], v[164:167], v[172:175], v[112:127]
    s_add_u32 m0, s60, 3072
    s_nop 0
    buffer_load_dwordx4 v13, s[24:27], s9 offen lds
    v_fma_f32 v47, v45, v44, v47
    v_mul_f32 v34, v46, v46
    s_waitcnt lgkmcnt(4)
    v_mfma_f32_32x32x16_bf16 v[64:79], v[128:131], v[136:139], v[64:79]
    v_add_u32 v19, 32768, v19
    v_add_u32 v23, 32768, v23
    v_mul_f32 v35, v46, v47
    v_fma_f32 v34, -v47, v47, v34
    v_fma_f32 v35, v47, v46, v35
    v_mfma_f32_32x32x16_bf16 v[96:111], v[128:131], v[140:143], v[96:111]
    ds_read_b128 v[160:163], v19
    ds_read_b128 v[168:171], v23
    s_add_u32 m0, s61, 16384
    s_nop 0
    buffer_load_dwordx4 v14, s[28:31], s9 offen lds
    v_cmp_lt_u32 vcc, 31, v1
    s_nop 1
    v_cndmask_b32 v44, 1.0, v30, vcc
    v_mfma_f32_32x32x16_bf16 v[80:95], v[132:135], v[136:139], v[80:95]
    ds_read_b128 v[172:175], v23 offset:8192
    ds_read_b128 v[164:167], v19 offset:4096
    v_cndmask_b32 v45, 0, v31, vcc
    v_cmp_ne_u32 vcc, 0, v7
    s_nop 1
    v_cndmask_b32 v46, 1.0, v48, vcc
    v_mfma_f32_32x32x16_bf16 v[112:127], v[132:135], v[140:143], v[112:127]
    s_add_u32 m0, s61, 17408
    s_nop 0
    buffer_load_dwordx4 v15, s[28:31], s9 offen lds
    v_cndmask_b32 v47, 0, v49, vcc
    v_mul_f32 v50, v44, v46
    v_mul_f32 v51, v44, v47
    s_waitcnt lgkmcnt(4)
    v_mfma_f32_32x32x16_bf16 v[64:79], v[144:147], v[152:155], v[64:79]
    s_waitcnt vmcnt(14)
    s_barrier
    v_add_u32 v16, 32768, v16
    v_add_u32 v20, 32768, v20
    s_add_u32 m0, s61, 24576
    s_nop 0
    buffer_load_dwordx4 v14, s[32:35], s9 offen lds
    v_fma_f32 v50, -v45, v47, v50
    v_fma_f32 v51, v45, v46, v51
    v_mfma_f32_32x32x16_bf16 v[96:111], v[144:147], v[156:159], v[96:111]
    ds_read_b128 v[128:131], v16
    ds_read_b128 v[136:139], v20
    v_mul_f32 v44, v50, v26
    v_mul_f32 v45, v50, v27
    v_fma_f32 v44, -v51, v27, v44
    v_mfma_f32_32x32x16_bf16 v[80:95], v[148:151], v[152:155], v[80:95]
    ds_read_b128 v[140:143], v20 offset:8192
    ds_read_b128 v[132:135], v16 offset:4096
    s_add_u32 m0, s61, 25600
    s_nop 0
    buffer_load_dwordx4 v15, s[32:35], s9 offen lds
    v_fma_f32 v45, v51, v26, v45
    v_mul_f32 v46, v44, v28
    v_mfma_f32_32x32x16_bf16 v[112:127], v[148:151], v[156:159], v[112:127]
    v_mul_f32 v47, v44, v29
    v_fma_f32 v46, -v45, v29, v46
    v_fma_f32 v47, v45, v28, v47
    s_waitcnt lgkmcnt(4)
    v_mfma_f32_32x32x16_bf16 v[64:79], v[160:163], v[168:171], v[64:79]
    v_add_u32 v17, 32768, v17
    v_add_u32 v21, 32768, v21
    s_add_u32 m0, s60, 32768
    s_nop 0
    buffer_load_dwordx4 v10, s[24:27], s10 offen lds
    v_mov_b32 v36, v44
    v_mov_b32_e64 v37, v46
    v_mfma_f32_32x32x16_bf16 v[96:111], v[160:163], v[172:175], v[96:111]
    ds_read_b128 v[144:147], v17
    ds_read_b128 v[152:155], v21
    v_mov_b32 v38, v45
    v_mov_b32 v39, v47
    s_add_u32 s18, s69, 1024
    v_mfma_f32_32x32x16_bf16 v[80:95], v[164:167], v[168:171], v[80:95]
    ds_read_b128 v[156:159], v21 offset:8192
    ds_read_b128 v[148:151], v17 offset:4096
    s_add_u32 m0, s60, 33792
    s_nop 0
    buffer_load_dwordx4 v11, s[24:27], s10 offen lds
    s_and_b32 s48, s20, 1
    v_lshrrev_b32 v2, 3, v1
    v_xor_b32 v2, s48, v2
    v_mfma_f32_32x32x16_bf16 v[112:127], v[164:167], v[172:175], v[112:127]
    s_add_u32 m0, s60, 34816
    s_nop 0
    buffer_load_dwordx4 v12, s[24:27], s10 offen lds
    v_mov_b32 v3, s51
    v_cmp_ne_u32 vcc, s51, v2
    s_waitcnt lgkmcnt(4)
    v_mfma_f32_32x32x16_bf16 v[64:79], v[128:131], v[136:139], v[64:79]
    v_add_u32 v18, 32768, v18
    v_add_u32 v22, 32768, v22
    v_cndmask_b32 v4, 0, v2, vcc
    v_cmp_eq_u32 vcc, 0, v2
    s_nop 1
    v_cndmask_b32 v4, v4, v3, vcc
    v_mfma_f32_32x32x16_bf16 v[96:111], v[128:131], v[140:143], v[96:111]
    ds_read_b128 v[160:163], v18
    ds_read_b128 v[168:171], v22
    s_add_u32 m0, s60, 35840
    s_nop 0
    buffer_load_dwordx4 v13, s[24:27], s10 offen lds
    v_and_b32_e64 v2, 7, v1
    v_lshlrev_b32 v2, 4, v2
    v_mfma_f32_32x32x16_bf16 v[80:95], v[132:135], v[136:139], v[80:95]
    ds_read_b128 v[172:175], v22 offset:8192
    ds_read_b128 v[164:167], v18 offset:4096
    v_lshl_add_u32 v4, v4, 7, v2
    v_xor_b32_e64 v224, 0, v4
    v_add_u32 v224, 0, v224
    v_mfma_f32_32x32x16_bf16 v[112:127], v[132:135], v[140:143], v[112:127]
    s_add_u32 m0, s61, 49152
    s_nop 0
    buffer_load_dwordx4 v14, s[28:31], s10 offen lds
    v_xor_b32 v225, 16, v4
    v_add_u32 v225, 2048, v225
    s_waitcnt lgkmcnt(4)
    v_mfma_f32_32x32x16_bf16 v[64:79], v[144:147], v[152:155], v[64:79]
    v_add_u32 v19, 32768, v19
    v_add_u32 v23, 32768, v23
    v_xor_b32_e64 v226, 32, v4
    v_add_u32 v226, 4096, v226
    v_xor_b32 v227, 48, v4
    v_mfma_f32_32x32x16_bf16 v[96:111], v[144:147], v[156:159], v[96:111]
    ds_read_b128 v[128:131], v19
    ds_read_b128 v[136:139], v23
    s_add_u32 m0, s61, 50176
    s_nop 0
    buffer_load_dwordx4 v15, s[28:31], s10 offen lds
    v_add_u32 v227, 6144, v227
    v_xor_b32 v228, 64, v4
    v_add_u32 v228, 8192, v228
    v_mfma_f32_32x32x16_bf16 v[80:95], v[148:151], v[152:155], v[80:95]
    ds_read_b128 v[140:143], v23 offset:8192
    ds_read_b128 v[132:135], v19 offset:4096
    v_xor_b32 v229, 80, v4
    v_add_u32 v229, 10240, v229
    v_mfma_f32_32x32x16_bf16 v[112:127], v[148:151], v[156:159], v[112:127]
    s_add_u32 m0, s61, 57344
    s_nop 0
    buffer_load_dwordx4 v14, s[32:35], s10 offen lds
    v_xor_b32 v230, 96, v4
    v_add_u32 v230, 12288, v230
    v_xor_b32 v231, 112, v4
    s_waitcnt lgkmcnt(4)
    v_mfma_f32_32x32x16_bf16 v[64:79], v[160:163], v[168:171], v[64:79]
    s_waitcnt vmcnt(15)
    s_barrier
    v_add_u32 v16, 32768, v16
    v_add_u32 v20, 32768, v20
    s_add_u32 m0, s61, 58368
    s_nop 0
    buffer_load_dwordx4 v15, s[32:35], s10 offen lds
    v_add_u32 v231, 14336, v231
    v_mfma_f32_32x32x16_bf16 v[96:111], v[160:163], v[172:175], v[96:111]
    ds_read_b128 v[144:147], v16
    ds_read_b128 v[152:155], v20
    v_mfma_f32_32x32x16_bf16 v[80:95], v[164:167], v[168:171], v[80:95]
    ds_read_b128 v[156:159], v20 offset:8192
    ds_read_b128 v[148:151], v16 offset:4096
    s_add_u32 m0, s60, 65536
    s_nop 0
    buffer_load_dwordx4 v10, s[24:27], s11 offen lds
    v_mfma_f32_32x32x16_bf16 v[112:127], v[164:167], v[172:175], v[112:127]
    s_waitcnt lgkmcnt(4)
    v_mfma_f32_32x32x16_bf16 v[64:79], v[128:131], v[136:139], v[64:79]
    v_add_u32 v17, 32768, v17
    v_add_u32 v21, 32768, v21
    s_add_u32 m0, s60, 66560
    s_nop 0
    buffer_load_dwordx4 v11, s[24:27], s11 offen lds
    v_mfma_f32_32x32x16_bf16 v[96:111], v[128:131], v[140:143], v[96:111]
    ds_read_b128 v[160:163], v17
    ds_read_b128 v[168:171], v21
    v_mfma_f32_32x32x16_bf16 v[80:95], v[132:135], v[136:139], v[80:95]
    ds_read_b128 v[172:175], v21 offset:8192
    ds_read_b128 v[164:167], v17 offset:4096
    s_add_u32 m0, s60, 67584
    s_nop 0
    buffer_load_dwordx4 v12, s[24:27], s11 offen lds
    v_mfma_f32_32x32x16_bf16 v[112:127], v[132:135], v[140:143], v[112:127]
    s_add_u32 m0, s60, 68608
    s_nop 0
    buffer_load_dwordx4 v13, s[24:27], s11 offen lds
    s_waitcnt lgkmcnt(4)
    v_mfma_f32_32x32x16_bf16 v[64:79], v[144:147], v[152:155], v[64:79]
    v_add_u32 v18, 32768, v18
    v_add_u32 v22, 32768, v22
    v_mfma_f32_32x32x16_bf16 v[96:111], v[144:147], v[156:159], v[96:111]
    ds_read_b128 v[128:131], v18
    ds_read_b128 v[136:139], v22
    s_add_u32 m0, s61, 81920
    s_nop 0
    buffer_load_dwordx4 v14, s[28:31], s11 offen lds
    v_mfma_f32_32x32x16_bf16 v[80:95], v[148:151], v[152:155], v[80:95]
    ds_read_b128 v[140:143], v22 offset:8192
    ds_read_b128 v[132:135], v18 offset:4096
    v_mfma_f32_32x32x16_bf16 v[112:127], v[148:151], v[156:159], v[112:127]
    s_add_u32 m0, s61, 82944
    s_nop 0
    buffer_load_dwordx4 v15, s[28:31], s11 offen lds
    s_waitcnt lgkmcnt(4)
    v_mfma_f32_32x32x16_bf16 v[64:79], v[160:163], v[168:171], v[64:79]
    v_add_u32 v19, 32768, v19
    v_add_u32 v23, 32768, v23
    v_mfma_f32_32x32x16_bf16 v[96:111], v[160:163], v[172:175], v[96:111]
    ds_read_b128 v[144:147], v19
    ds_read_b128 v[152:155], v23
    s_add_u32 m0, s61, 90112
    s_nop 0
    buffer_load_dwordx4 v14, s[32:35], s11 offen lds
    v_mfma_f32_32x32x16_bf16 v[80:95], v[164:167], v[168:171], v[80:95]
    ds_read_b128 v[156:159], v23 offset:8192
    ds_read_b128 v[148:151], v19 offset:4096
    v_mfma_f32_32x32x16_bf16 v[112:127], v[164:167], v[172:175], v[112:127]
    s_add_u32 m0, s61, 91136
    s_nop 0
    buffer_load_dwordx4 v15, s[32:35], s11 offen lds
    s_waitcnt lgkmcnt(4)
    v_mfma_f32_32x32x16_bf16 v[64:79], v[128:131], v[136:139], v[64:79]
    s_waitcnt vmcnt(16)
    s_barrier
    v_subrev_u32 v16, 131072, v16
    v_subrev_u32 v20, 131072, v20
    v_mfma_f32_32x32x16_bf16 v[96:111], v[128:131], v[140:143], v[96:111]
    ds_read_b128 v[160:163], v16
    ds_read_b128 v[168:171], v20
    s_mov_b32 exec_hi, 0
    buffer_load_dword v40, v195, s[92:95], 0 offen
    buffer_load_dword v40, v195, s[96:99], 0 offen
    s_mov_b64 exec, -1
    v_mfma_f32_32x32x16_bf16 v[80:95], v[132:135], v[136:139], v[80:95]
    ds_read_b128 v[172:175], v20 offset:8192
    ds_read_b128 v[164:167], v16 offset:4096
    s_mov_b64 exec, 1
    buffer_store_dword v43, v42, s[36:39], s47 offen sc1
    s_mov_b64 exec, -1
    v_mfma_f32_32x32x16_bf16 v[112:127], v[132:135], v[140:143], v[112:127]
    s_waitcnt lgkmcnt(4)
    v_mfma_f32_32x32x16_bf16 v[64:79], v[144:147], v[152:155], v[64:79]
    v_subrev_u32 v17, 131072, v17
    v_subrev_u32 v21, 131072, v21
    v_mfma_f32_32x32x16_bf16 v[96:111], v[144:147], v[156:159], v[96:111]
    ds_read_b128 v[128:131], v17
    ds_read_b128 v[136:139], v21
    v_mfma_f32_32x32x16_bf16 v[80:95], v[148:151], v[152:155], v[80:95]
    ds_read_b128 v[140:143], v21 offset:8192
    ds_read_b128 v[132:135], v17 offset:4096
    v_mfma_f32_32x32x16_bf16 v[112:127], v[148:151], v[156:159], v[112:127]
    s_waitcnt lgkmcnt(4)
    v_mfma_f32_32x32x16_bf16 v[64:79], v[160:163], v[168:171], v[64:79]
    v_subrev_u32 v18, 131072, v18
    v_subrev_u32 v22, 131072, v22
    v_mfma_f32_32x32x16_bf16 v[96:111], v[160:163], v[172:175], v[96:111]
    ds_read_b128 v[144:147], v18
    ds_read_b128 v[152:155], v22
    v_mfma_f32_32x32x16_bf16 v[80:95], v[164:167], v[168:171], v[80:95]
    ds_read_b128 v[156:159], v22 offset:8192
    ds_read_b128 v[148:151], v18 offset:4096
    v_mfma_f32_32x32x16_bf16 v[112:127], v[164:167], v[172:175], v[112:127]
    s_waitcnt lgkmcnt(4)
    v_mfma_f32_32x32x16_bf16 v[64:79], v[128:131], v[136:139], v[64:79]
    v_subrev_u32 v19, 131072, v19
    v_subrev_u32 v23, 131072, v23
    v_mfma_f32_32x32x16_bf16 v[96:111], v[128:131], v[140:143], v[96:111]
    ds_read_b128 v[160:163], v19
    ds_read_b128 v[168:171], v23
    v_mfma_f32_32x32x16_bf16 v[80:95], v[132:135], v[136:139], v[80:95]
    ds_read_b128 v[172:175], v23 offset:8192
    ds_read_b128 v[164:167], v19 offset:4096
    v_mfma_f32_32x32x16_bf16 v[112:127], v[132:135], v[140:143], v[112:127]
    s_waitcnt lgkmcnt(4)
    v_mfma_f32_32x32x16_bf16 v[64:79], v[144:147], v[152:155], v[64:79]
    s_waitcnt vmcnt(11)
    s_barrier
    v_add_u32 v16, 32768, v16
    v_add_u32 v20, 32768, v20
    v_mfma_f32_32x32x16_bf16 v[96:111], v[144:147], v[156:159], v[96:111]
    ds_read_b128 v[128:131], v16
    ds_read_b128 v[136:139], v20
    v_mfma_f32_32x32x16_bf16 v[80:95], v[148:151], v[152:155], v[80:95]
    ds_read_b128 v[140:143], v20 offset:8192
    ds_read_b128 v[132:135], v16 offset:4096
    v_mfma_f32_32x32x16_bf16 v[112:127], v[148:151], v[156:159], v[112:127]
    s_waitcnt lgkmcnt(4)
    v_mfma_f32_32x32x16_bf16 v[64:79], v[160:163], v[168:171], v[64:79]
    v_add_u32 v17, 32768, v17
    v_add_u32 v21, 32768, v21
    v_mfma_f32_32x32x16_bf16 v[96:111], v[160:163], v[172:175], v[96:111]
    ds_read_b128 v[144:147], v17
    ds_read_b128 v[152:155], v21
    v_mfma_f32_32x32x16_bf16 v[80:95], v[164:167], v[168:171], v[80:95]
    ds_read_b128 v[156:159], v21 offset:8192
    ds_read_b128 v[148:151], v17 offset:4096
    v_mfma_f32_32x32x16_bf16 v[112:127], v[164:167], v[172:175], v[112:127]
    s_waitcnt lgkmcnt(4)
    v_mfma_f32_32x32x16_bf16 v[64:79], v[128:131], v[136:139], v[64:79]
    v_add_u32 v18, 32768, v18
    v_add_u32 v22, 32768, v22
    v_mfma_f32_32x32x16_bf16 v[96:111], v[128:131], v[140:143], v[96:111]
    ds_read_b128 v[160:163], v18
    ds_read_b128 v[168:171], v22
    v_mfma_f32_32x32x16_bf16 v[80:95], v[132:135], v[136:139], v[80:95]
    ds_read_b128 v[172:175], v22 offset:8192
    ds_read_b128 v[164:167], v18 offset:4096
    v_mfma_f32_32x32x16_bf16 v[112:127], v[132:135], v[140:143], v[112:127]
    s_waitcnt lgkmcnt(4)
    v_mfma_f32_32x32x16_bf16 v[64:79], v[144:147], v[152:155], v[64:79]
    v_add_u32 v19, 32768, v19
    v_add_u32 v23, 32768, v23
    v_mfma_f32_32x32x16_bf16 v[96:111], v[144:147], v[156:159], v[96:111]
    ds_read_b128 v[128:131], v19
    ds_read_b128 v[136:139], v23
    v_mfma_f32_32x32x16_bf16 v[80:95], v[148:151], v[152:155], v[80:95]
    ds_read_b128 v[140:143], v23 offset:8192
    ds_read_b128 v[132:135], v19 offset:4096
    v_mfma_f32_32x32x16_bf16 v[112:127], v[148:151], v[156:159], v[112:127]
    s_waitcnt lgkmcnt(4)
    v_mfma_f32_32x32x16_bf16 v[64:79], v[160:163], v[168:171], v[64:79]
    s_waitcnt vmcnt(3) lgkmcnt(0)
    s_barrier
    v_add_u32 v16, 32768, v16
    v_add_u32 v20, 32768, v20
    v_mfma_f32_32x32x16_bf16 v[96:111], v[160:163], v[172:175], v[96:111]
    ds_read_b128 v[144:147], v16
    ds_read_b128 v[152:155], v20
    v_mfma_f32_32x32x16_bf16 v[80:95], v[164:167], v[168:171], v[80:95]
    ds_read_b128 v[156:159], v20 offset:8192
    ds_read_b128 v[148:151], v16 offset:4096
    v_mfma_f32_32x32x16_bf16 v[112:127], v[164:167], v[172:175], v[112:127]
    v_mfma_f32_32x32x16_bf16 v[64:79], v[128:131], v[136:139], v[64:79]
    v_add_u32 v17, 32768, v17
    v_add_u32 v21, 32768, v21
    v_mfma_f32_32x32x16_bf16 v[96:111], v[128:131], v[140:143], v[96:111]
    ds_read_b128 v[160:163], v17
    ds_read_b128 v[168:171], v21
    v_mfma_f32_32x32x16_bf16 v[80:95], v[132:135], v[136:139], v[80:95]
    ds_read_b128 v[172:175], v21 offset:8192
    ds_read_b128 v[164:167], v17 offset:4096
    s_add_u32 m0, s44, 98304
    s_nop 0
    buffer_load_dwordx4 v224, s[92:95], s69 offen lds
    v_mfma_f32_32x32x16_bf16 v[112:127], v[132:135], v[140:143], v[112:127]
    s_waitcnt lgkmcnt(4)
    v_mfma_f32_32x32x16_bf16 v[64:79], v[144:147], v[152:155], v[64:79]
    v_add_u32 v18, 32768, v18
    v_add_u32 v22, 32768, v22
    s_add_u32 m0, s44, 99328
    s_nop 0
    buffer_load_dwordx4 v225, s[92:95], s69 offen lds
    v_mfma_f32_32x32x16_bf16 v[96:111], v[144:147], v[156:159], v[96:111]
    ds_read_b128 v[128:131], v18
    ds_read_b128 v[136:139], v22
    v_mfma_f32_32x32x16_bf16 v[80:95], v[148:151], v[152:155], v[80:95]
    ds_read_b128 v[140:143], v22 offset:8192
    ds_read_b128 v[132:135], v18 offset:4096
    s_add_u32 m0, s44, 100352
    s_nop 0
    buffer_load_dwordx4 v226, s[92:95], s69 offen lds
    v_mfma_f32_32x32x16_bf16 v[112:127], v[148:151], v[156:159], v[112:127]
    s_waitcnt lgkmcnt(4)
    v_mfma_f32_32x32x16_bf16 v[64:79], v[160:163], v[168:171], v[64:79]
    v_add_u32 v19, 32768, v19
    v_add_u32 v23, 32768, v23
    s_add_u32 m0, s44, 101376
    s_nop 0
    buffer_load_dwordx4 v227, s[92:95], s69 offen lds
    v_mfma_f32_32x32x16_bf16 v[96:111], v[160:163], v[172:175], v[96:111]
    ds_read_b128 v[144:147], v19
    ds_read_b128 v[152:155], v23
    v_mfma_f32_32x32x16_bf16 v[80:95], v[164:167], v[168:171], v[80:95]
    ds_read_b128 v[156:159], v23 offset:8192
    ds_read_b128 v[148:151], v19 offset:4096
    s_add_u32 m0, s44, 102400
    s_nop 0
    buffer_load_dwordx4 v228, s[92:95], s69 offen lds
    v_mfma_f32_32x32x16_bf16 v[112:127], v[164:167], v[172:175], v[112:127]
    s_waitcnt lgkmcnt(4)
    v_mfma_f32_32x32x16_bf16 v[64:79], v[128:131], v[136:139], v[64:79]
    s_add_u32 m0, s44, 103424
    s_nop 0
    buffer_load_dwordx4 v229, s[92:95], s69 offen lds
    v_mfma_f32_32x32x16_bf16 v[96:111], v[128:131], v[140:143], v[96:111]
    v_mfma_f32_32x32x16_bf16 v[80:95], v[132:135], v[136:139], v[80:95]
    s_add_u32 m0, s44, 104448
    s_nop 0
    buffer_load_dwordx4 v230, s[92:95], s69 offen lds
    v_mfma_f32_32x32x16_bf16 v[112:127], v[132:135], v[140:143], v[112:127]
    s_waitcnt lgkmcnt(0)
    s_barrier
    v_mfma_f32_32x32x16_bf16 v[64:79], v[144:147], v[152:155], v[64:79]
    s_add_u32 m0, s44, 105472
    s_nop 0
    buffer_load_dwordx4 v231, s[92:95], s69 offen lds
    v_mfma_f32_32x32x16_bf16 v[96:111], v[144:147], v[156:159], v[96:111]
    v_mfma_f32_32x32x16_bf16 v[80:95], v[148:151], v[152:155], v[80:95]
    v_mfma_f32_32x32x16_bf16 v[112:127], v[148:151], v[156:159], v[112:127]
    s_nop 9
    v_pk_fma_f32 v[50:51], v[24:25], v[64:65], v[98:99] op_sel:[1,0,0] op_sel_hi:[1,1,1]
    v_pk_fma_f32 v[48:49], v[24:25], v[96:97], v[66:67] op_sel:[1,0,0] op_sel_hi:[1,1,1] neg_lo:[1,0,0] neg_hi:[1,0,0]
    v_pk_fma_f32 v[48:49], v[24:25], v[64:65], v[48:49] op_sel:[0,0,0] op_sel_hi:[0,1,1]
    v_pk_fma_f32 v[50:51], v[24:25], v[96:97], v[50:51] op_sel:[0,0,0] op_sel_hi:[0,1,1]
    v_pk_fma_f32 v[46:47], v[24:25], v[48:49], v[100:101] op_sel:[1,0,0] op_sel_hi:[1,1,1]
    v_pk_fma_f32 v[44:45], v[24:25], v[50:51], v[68:69] op_sel:[1,0,0] op_sel_hi:[1,1,1] neg_lo:[1,0,0] neg_hi:[1,0,0]
    v_pk_fma_f32 v[44:45], v[24:25], v[48:49], v[44:45] op_sel:[0,0,0] op_sel_hi:[0,1,1]
    v_pk_fma_f32 v[46:47], v[24:25], v[50:51], v[46:47] op_sel:[0,0,0] op_sel_hi:[0,1,1]
    v_pk_fma_f32 v[50:51], v[24:25], v[44:45], v[102:103] op_sel:[1,0,0] op_sel_hi:[1,1,1]
    v_pk_fma_f32 v[48:49], v[24:25], v[46:47], v[70:71] op_sel:[1,0,0] op_sel_hi:[1,1,1] neg_lo:[1,0,0] neg_hi:[1,0,0]
    v_pk_fma_f32 v[48:49], v[24:25], v[44:45], v[48:49] op_sel:[0,0,0] op_sel_hi:[0,1,1]
    v_pk_fma_f32 v[50:51], v[24:25], v[46:47], v[50:51] op_sel:[0,0,0] op_sel_hi:[0,1,1]
    v_pk_fma_f32 v[46:47], v[24:25], v[48:49], v[104:105] op_sel:[1,0,0] op_sel_hi:[1,1,1]
    v_pk_fma_f32 v[44:45], v[24:25], v[50:51], v[72:73] op_sel:[1,0,0] op_sel_hi:[1,1,1] neg_lo:[1,0,0] neg_hi:[1,0,0]
    v_pk_fma_f32 v[44:45], v[24:25], v[48:49], v[44:45] op_sel:[0,0,0] op_sel_hi:[0,1,1]
    v_pk_fma_f32 v[46:47], v[24:25], v[50:51], v[46:47] op_sel:[0,0,0] op_sel_hi:[0,1,1]
    v_pk_fma_f32 v[50:51], v[24:25], v[44:45], v[106:107] op_sel:[1,0,0] op_sel_hi:[1,1,1]
    v_pk_fma_f32 v[48:49], v[24:25], v[46:47], v[74:75] op_sel:[1,0,0] op_sel_hi:[1,1,1] neg_lo:[1,0,0] neg_hi:[1,0,0]
    v_pk_fma_f32 v[48:49], v[24:25], v[44:45], v[48:49] op_sel:[0,0,0] op_sel_hi:[0,1,1]
    v_pk_fma_f32 v[50:51], v[24:25], v[46:47], v[50:51] op_sel:[0,0,0] op_sel_hi:[0,1,1]
    v_pk_fma_f32 v[46:47], v[24:25], v[48:49], v[108:109] op_sel:[1,0,0] op_sel_hi:[1,1,1]
    v_pk_fma_f32 v[44:45], v[24:25], v[50:51], v[76:77] op_sel:[1,0,0] op_sel_hi:[1,1,1] neg_lo:[1,0,0] neg_hi:[1,0,0]
    v_pk_fma_f32 v[44:45], v[24:25], v[48:49], v[44:45] op_sel:[0,0,0] op_sel_hi:[0,1,1]
    v_pk_fma_f32 v[46:47], v[24:25], v[50:51], v[46:47] op_sel:[0,0,0] op_sel_hi:[0,1,1]
    v_pk_fma_f32 v[50:51], v[24:25], v[44:45], v[110:111] op_sel:[1,0,0] op_sel_hi:[1,1,1]
    v_pk_fma_f32 v[48:49], v[24:25], v[46:47], v[78:79] op_sel:[1,0,0] op_sel_hi:[1,1,1] neg_lo:[1,0,0] neg_hi:[1,0,0]
    v_pk_fma_f32 v[48:49], v[24:25], v[44:45], v[48:49] op_sel:[0,0,0] op_sel_hi:[0,1,1]
    v_pk_fma_f32 v[50:51], v[24:25], v[46:47], v[50:51] op_sel:[0,0,0] op_sel_hi:[0,1,1]
    v_pk_fma_f32 v[46:47], v[24:25], v[48:49], v[112:113] op_sel:[1,0,0] op_sel_hi:[1,1,1]
    v_pk_fma_f32 v[44:45], v[24:25], v[50:51], v[80:81] op_sel:[1,0,0] op_sel_hi:[1,1,1] neg_lo:[1,0,0] neg_hi:[1,0,0]
    v_pk_fma_f32 v[44:45], v[24:25], v[48:49], v[44:45] op_sel:[0,0,0] op_sel_hi:[0,1,1]
    v_pk_fma_f32 v[46:47], v[24:25], v[50:51], v[46:47] op_sel:[0,0,0] op_sel_hi:[0,1,1]
    v_pk_fma_f32 v[50:51], v[24:25], v[44:45], v[114:115] op_sel:[1,0,0] op_sel_hi:[1,1,1]
    v_pk_fma_f32 v[48:49], v[24:25], v[46:47], v[82:83] op_sel:[1,0,0] op_sel_hi:[1,1,1] neg_lo:[1,0,0] neg_hi:[1,0,0]
    v_pk_fma_f32 v[48:49], v[24:25], v[44:45], v[48:49] op_sel:[0,0,0] op_sel_hi:[0,1,1]
    v_pk_fma_f32 v[50:51], v[24:25], v[46:47], v[50:51] op_sel:[0,0,0] op_sel_hi:[0,1,1]
    v_pk_fma_f32 v[46:47], v[24:25], v[48:49], v[116:117] op_sel:[1,0,0] op_sel_hi:[1,1,1]
    v_pk_fma_f32 v[44:45], v[24:25], v[50:51], v[84:85] op_sel:[1,0,0] op_sel_hi:[1,1,1] neg_lo:[1,0,0] neg_hi:[1,0,0]
    v_pk_fma_f32 v[44:45], v[24:25], v[48:49], v[44:45] op_sel:[0,0,0] op_sel_hi:[0,1,1]
    v_pk_fma_f32 v[46:47], v[24:25], v[50:51], v[46:47] op_sel:[0,0,0] op_sel_hi:[0,1,1]
    v_pk_fma_f32 v[50:51], v[24:25], v[44:45], v[118:119] op_sel:[1,0,0] op_sel_hi:[1,1,1]
    v_pk_fma_f32 v[48:49], v[24:25], v[46:47], v[86:87] op_sel:[1,0,0] op_sel_hi:[1,1,1] neg_lo:[1,0,0] neg_hi:[1,0,0]
    v_pk_fma_f32 v[48:49], v[24:25], v[44:45], v[48:49] op_sel:[0,0,0] op_sel_hi:[0,1,1]
    v_pk_fma_f32 v[50:51], v[24:25], v[46:47], v[50:51] op_sel:[0,0,0] op_sel_hi:[0,1,1]
    v_pk_fma_f32 v[46:47], v[24:25], v[48:49], v[120:121] op_sel:[1,0,0] op_sel_hi:[1,1,1]
    v_pk_fma_f32 v[44:45], v[24:25], v[50:51], v[88:89] op_sel:[1,0,0] op_sel_hi:[1,1,1] neg_lo:[1,0,0] neg_hi:[1,0,0]
    v_pk_fma_f32 v[44:45], v[24:25], v[48:49], v[44:45] op_sel:[0,0,0] op_sel_hi:[0,1,1]
    v_pk_fma_f32 v[46:47], v[24:25], v[50:51], v[46:47] op_sel:[0,0,0] op_sel_hi:[0,1,1]
    v_pk_fma_f32 v[50:51], v[24:25], v[44:45], v[122:123] op_sel:[1,0,0] op_sel_hi:[1,1,1]
    v_pk_fma_f32 v[48:49], v[24:25], v[46:47], v[90:91] op_sel:[1,0,0] op_sel_hi:[1,1,1] neg_lo:[1,0,0] neg_hi:[1,0,0]
    v_pk_fma_f32 v[48:49], v[24:25], v[44:45], v[48:49] op_sel:[0,0,0] op_sel_hi:[0,1,1]
    v_pk_fma_f32 v[50:51], v[24:25], v[46:47], v[50:51] op_sel:[0,0,0] op_sel_hi:[0,1,1]
    v_pk_fma_f32 v[46:47], v[24:25], v[48:49], v[124:125] op_sel:[1,0,0] op_sel_hi:[1,1,1]
    v_pk_fma_f32 v[44:45], v[24:25], v[50:51], v[92:93] op_sel:[1,0,0] op_sel_hi:[1,1,1] neg_lo:[1,0,0] neg_hi:[1,0,0]
    v_pk_fma_f32 v[44:45], v[24:25], v[48:49], v[44:45] op_sel:[0,0,0] op_sel_hi:[0,1,1]
    v_pk_fma_f32 v[46:47], v[24:25], v[50:51], v[46:47] op_sel:[0,0,0] op_sel_hi:[0,1,1]
    v_pk_fma_f32 v[50:51], v[24:25], v[44:45], v[126:127] op_sel:[1,0,0] op_sel_hi:[1,1,1]
    v_pk_fma_f32 v[48:49], v[24:25], v[46:47], v[94:95] op_sel:[1,0,0] op_sel_hi:[1,1,1] neg_lo:[1,0,0] neg_hi:[1,0,0]
    v_pk_fma_f32 v[48:49], v[24:25], v[44:45], v[48:49] op_sel:[0,0,0] op_sel_hi:[0,1,1]
    v_pk_fma_f32 v[50:51], v[24:25], v[46:47], v[50:51] op_sel:[0,0,0] op_sel_hi:[0,1,1]
    v_mov_b32 v52, v48
    v_mov_b32 v53, v50
    v_mov_b32 v54, v49
    v_mov_b32 v55, v51
    v_pk_fma_f32 v[54:55], v[28:29], v[52:53], v[54:55] op_sel:[0,0,0] op_sel_hi:[0,1,1]
    v_pk_fma_f32 v[54:55], v[28:29], v[52:53], v[54:55] op_sel:[1,1,0] op_sel_hi:[1,0,1] neg_lo:[1,0,0]
    ds_write_b64 v184, v[54:55]
    v_mov_b32 v141, s3
    v_mov_b32_e64 v143, s3
    s_waitcnt lgkmcnt(0)
    s_barrier
    ds_read_b64 v[128:129], v185 offset:0
    ds_read_b64 v[130:131], v185 offset:512
    ds_read_b64 v[132:133], v185 offset:1024
    ds_read_b64 v[134:135], v185 offset:1536
    s_waitcnt lgkmcnt(0)
    v_pk_fma_f32 v[130:131], v[30:31], v[128:129], v[130:131] op_sel:[0,0,0] op_sel_hi:[0,1,1]
    v_pk_fma_f32 v[130:131], v[30:31], v[128:129], v[130:131] op_sel:[1,1,0] op_sel_hi:[1,0,1] neg_lo:[1,0,0]
    v_pk_fma_f32 v[132:133], v[30:31], v[130:131], v[132:133] op_sel:[0,0,0] op_sel_hi:[0,1,1]
    v_pk_fma_f32 v[132:133], v[30:31], v[130:131], v[132:133] op_sel:[1,1,0] op_sel_hi:[1,0,1] neg_lo:[1,0,0]
    v_pk_fma_f32 v[134:135], v[30:31], v[132:133], v[134:135] op_sel:[0,0,0] op_sel_hi:[0,1,1]
    v_pk_fma_f32 v[134:135], v[30:31], v[132:133], v[134:135] op_sel:[1,1,0] op_sel_hi:[1,0,1] neg_lo:[1,0,0]
    v_mov_b32_e64 v140, v134
    v_mov_b32 v142, v135
    s_cmp_ge_u32 s20, 2
    s_cbranch_scc1 Lpub_11
    s_mov_b32 exec_hi, 0
    buffer_store_dwordx4 v[140:143], v186, s[64:67], s54 offen sc1
    s_mov_b64 exec, -1
Lpub_11:
    s_barrier
    v_and_b32 v5, 7, v1
    v_lshlrev_b32 v5, 7, v5
    buffer_load_dword v196, v5, s[36:39], s47 offen sc1
    v_cmp_lt_u32 vcc, 31, v1
    s_nop 1
    v_cndmask_b32 v136, 0, v128, vcc
    v_cndmask_b32 v137, 0, v129, vcc
    v_cndmask_b32 v138, v130, v132, vcc
    s_add_u32 m0, s44, 131072
    s_nop 0
    buffer_load_dwordx4 v224, s[92:95], s18 offen lds
    v_cndmask_b32 v139, v131, v133, vcc
    v_cmp_ne_u32 vcc, 0, v7
    s_nop 1
    v_cndmask_b32 v136, v136, v138, vcc
    v_cndmask_b32 v137, v137, v139, vcc
    s_add_u32 m0, s44, 132096
    s_nop 0
    buffer_load_dwordx4 v225, s[92:95], s18 offen lds
    v_pk_fma_f32 v[52:53], v[28:29], v[136:137], v[52:53] op_sel:[0,0,0] op_sel_hi:[0,1,1]
    v_pk_fma_f32 v[52:53], v[28:29], v[136:137], v[52:53] op_sel:[1,1,0] op_sel_hi:[1,0,1] neg_lo:[1,0,0]
    v_mul_f32 v138, v26, v136
    v_mul_f32 v139, v26, v137
    v_fma_f32 v138, -v27, v137, v138
    v_fma_f32 v139, v27, v136, v139
    v_mul_f32 v144, v26, v52
    v_mul_f32 v145, v26, v53
    v_fma_f32 v144, -v27, v53, v144
    v_fma_f32 v145, v27, v52, v145
    v_mov_b32 v56, v138
    v_mov_b32 v57, v144
    v_mov_b32_e64 v58, v139
    v_mov_b32 v59, v145
    s_add_u32 m0, s44, 133120
    s_nop 0
    buffer_load_dwordx4 v226, s[92:95], s18 offen lds
    v_pk_mul_f32 v[44:45], v[26:27], v[64:65] op_sel:[1,0] op_sel_hi:[1,1]
    v_pk_mul_f32 v[64:65], v[26:27], v[64:65] op_sel:[0,0] op_sel_hi:[0,1]
    v_pk_fma_f32 v[64:65], v[26:27], v[96:97], v[64:65] op_sel:[1,0,0] op_sel_hi:[1,1,1] neg_lo:[1,0,0] neg_hi:[1,0,0]
    v_pk_fma_f32 v[96:97], v[26:27], v[96:97], v[44:45] op_sel:[0,0,0] op_sel_hi:[0,1,1]
    s_add_u32 m0, s44, 134144
    s_nop 0
    buffer_load_dwordx4 v227, s[92:95], s18 offen lds
    v_pk_mul_f32 v[46:47], v[26:27], v[66:67] op_sel:[1,0] op_sel_hi:[1,1]
    v_pk_mul_f32 v[66:67], v[26:27], v[66:67] op_sel:[0,0] op_sel_hi:[0,1]
    v_pk_fma_f32 v[66:67], v[26:27], v[98:99], v[66:67] op_sel:[1,0,0] op_sel_hi:[1,1,1] neg_lo:[1,0,0] neg_hi:[1,0,0]
    v_pk_fma_f32 v[98:99], v[26:27], v[98:99], v[46:47] op_sel:[0,0,0] op_sel_hi:[0,1,1]
    s_add_u32 m0, s44, 135168
    s_nop 0
    buffer_load_dwordx4 v228, s[92:95], s18 offen lds
    v_pk_mul_f32 v[44:45], v[26:27], v[68:69] op_sel:[1,0] op_sel_hi:[1,1]
    v_pk_mul_f32 v[68:69], v[26:27], v[68:69] op_sel:[0,0] op_sel_hi:[0,1]
    v_pk_fma_f32 v[68:69], v[26:27], v[100:101], v[68:69] op_sel:[1,0,0] op_sel_hi:[1,1,1] neg_lo:[1,0,0] neg_hi:[1,0,0]
    v_pk_fma_f32 v[100:101], v[26:27], v[100:101], v[44:45] op_sel:[0,0,0] op_sel_hi:[0,1,1]
    s_add_u32 m0, s44, 136192
    s_nop 0
    buffer_load_dwordx4 v229, s[92:95], s18 offen lds
    v_pk_mul_f32 v[46:47], v[26:27], v[70:71] op_sel:[1,0] op_sel_hi:[1,1]
    v_pk_mul_f32 v[70:71], v[26:27], v[70:71] op_sel:[0,0] op_sel_hi:[0,1]
    v_pk_fma_f32 v[70:71], v[26:27], v[102:103], v[70:71] op_sel:[1,0,0] op_sel_hi:[1,1,1] neg_lo:[1,0,0] neg_hi:[1,0,0]
    v_pk_fma_f32 v[102:103], v[26:27], v[102:103], v[46:47] op_sel:[0,0,0] op_sel_hi:[0,1,1]
    s_add_u32 m0, s44, 137216
    s_nop 0
    buffer_load_dwordx4 v230, s[92:95], s18 offen lds
    v_pk_mul_f32 v[44:45], v[26:27], v[72:73] op_sel:[1,0] op_sel_hi:[1,1]
    v_pk_mul_f32 v[72:73], v[26:27], v[72:73] op_sel:[0,0] op_sel_hi:[0,1]
    v_pk_fma_f32 v[72:73], v[26:27], v[104:105], v[72:73] op_sel:[1,0,0] op_sel_hi:[1,1,1] neg_lo:[1,0,0] neg_hi:[1,0,0]
    v_pk_fma_f32 v[104:105], v[26:27], v[104:105], v[44:45] op_sel:[0,0,0] op_sel_hi:[0,1,1]
    s_add_u32 m0, s44, 138240
    s_nop 0
    buffer_load_dwordx4 v231, s[92:95], s18 offen lds
    v_pk_mul_f32 v[46:47], v[26:27], v[74:75] op_sel:[1,0] op_sel_hi:[1,1]
    v_pk_mul_f32 v[74:75], v[26:27], v[74:75] op_sel:[0,0] op_sel_hi:[0,1]
    v_pk_fma_f32 v[74:75], v[26:27], v[106:107], v[74:75] op_sel:[1,0,0] op_sel_hi:[1,1,1] neg_lo:[1,0,0] neg_hi:[1,0,0]
    v_pk_fma_f32 v[106:107], v[26:27], v[106:107], v[46:47] op_sel:[0,0,0] op_sel_hi:[0,1,1]
    s_add_u32 m0, s44, 0
    s_nop 0
    buffer_load_dwordx4 v224, s[96:99], s69 offen lds
    v_pk_mul_f32 v[44:45], v[26:27], v[76:77] op_sel:[1,0] op_sel_hi:[1,1]
    v_pk_mul_f32 v[76:77], v[26:27], v[76:77] op_sel:[0,0] op_sel_hi:[0,1]
    v_pk_fma_f32 v[76:77], v[26:27], v[108:109], v[76:77] op_sel:[1,0,0] op_sel_hi:[1,1,1] neg_lo:[1,0,0] neg_hi:[1,0,0]
    v_pk_fma_f32 v[108:109], v[26:27], v[108:109], v[44:45] op_sel:[0,0,0] op_sel_hi:[0,1,1]
    s_add_u32 m0, s44, 1024
    s_nop 0
    buffer_load_dwordx4 v225, s[96:99], s69 offen lds
    v_pk_mul_f32 v[46:47], v[26:27], v[78:79] op_sel:[1,0] op_sel_hi:[1,1]
    v_pk_mul_f32 v[78:79], v[26:27], v[78:79] op_sel:[0,0] op_sel_hi:[0,1]
    v_pk_fma_f32 v[78:79], v[26:27], v[110:111], v[78:79] op_sel:[1,0,0] op_sel_hi:[1,1,1] neg_lo:[1,0,0] neg_hi:[1,0,0]
    v_pk_fma_f32 v[110:111], v[26:27], v[110:111], v[46:47] op_sel:[0,0,0] op_sel_hi:[0,1,1]
    s_add_u32 m0, s44, 2048
    s_nop 0
    buffer_load_dwordx4 v226, s[96:99], s69 offen lds
    v_pk_mul_f32 v[44:45], v[26:27], v[80:81] op_sel:[1,0] op_sel_hi:[1,1]
    v_pk_mul_f32 v[80:81], v[26:27], v[80:81] op_sel:[0,0] op_sel_hi:[0,1]
    v_pk_fma_f32 v[80:81], v[26:27], v[112:113], v[80:81] op_sel:[1,0,0] op_sel_hi:[1,1,1] neg_lo:[1,0,0] neg_hi:[1,0,0]
    v_pk_fma_f32 v[112:113], v[26:27], v[112:113], v[44:45] op_sel:[0,0,0] op_sel_hi:[0,1,1]
    s_add_u32 m0, s44, 3072
    s_nop 0
    buffer_load_dwordx4 v227, s[96:99], s69 offen lds
    v_pk_mul_f32 v[46:47], v[26:27], v[82:83] op_sel:[1,0] op_sel_hi:[1,1]
    v_pk_mul_f32 v[82:83], v[26:27], v[82:83] op_sel:[0,0] op_sel_hi:[0,1]
    v_pk_fma_f32 v[82:83], v[26:27], v[114:115], v[82:83] op_sel:[1,0,0] op_sel_hi:[1,1,1] neg_lo:[1,0,0] neg_hi:[1,0,0]
    v_pk_fma_f32 v[114:115], v[26:27], v[114:115], v[46:47] op_sel:[0,0,0] op_sel_hi:[0,1,1]
    s_add_u32 m0, s44, 4096
    s_nop 0
    buffer_load_dwordx4 v228, s[96:99], s69 offen lds
    v_pk_mul_f32 v[44:45], v[26:27], v[84:85] op_sel:[1,0] op_sel_hi:[1,1]
    v_pk_mul_f32 v[84:85], v[26:27], v[84:85] op_sel:[0,0] op_sel_hi:[0,1]
    v_pk_fma_f32 v[84:85], v[26:27], v[116:117], v[84:85] op_sel:[1,0,0] op_sel_hi:[1,1,1] neg_lo:[1,0,0] neg_hi:[1,0,0]
    v_pk_fma_f32 v[116:117], v[26:27], v[116:117], v[44:45] op_sel:[0,0,0] op_sel_hi:[0,1,1]
    s_add_u32 m0, s44, 5120
    s_nop 0
    buffer_load_dwordx4 v229, s[96:99], s69 offen lds
    v_pk_mul_f32 v[46:47], v[26:27], v[86:87] op_sel:[1,0] op_sel_hi:[1,1]
    v_pk_mul_f32 v[86:87], v[26:27], v[86:87] op_sel:[0,0] op_sel_hi:[0,1]
    v_pk_fma_f32 v[86:87], v[26:27], v[118:119], v[86:87] op_sel:[1,0,0] op_sel_hi:[1,1,1] neg_lo:[1,0,0] neg_hi:[1,0,0]
    v_pk_fma_f32 v[118:119], v[26:27], v[118:119], v[46:47] op_sel:[0,0,0] op_sel_hi:[0,1,1]
    s_add_u32 m0, s44, 6144
    s_nop 0
    buffer_load_dwordx4 v230, s[96:99], s69 offen lds
    v_pk_mul_f32 v[44:45], v[26:27], v[88:89] op_sel:[1,0] op_sel_hi:[1,1]
    v_pk_mul_f32 v[88:89], v[26:27], v[88:89] op_sel:[0,0] op_sel_hi:[0,1]
    v_pk_fma_f32 v[88:89], v[26:27], v[120:121], v[88:89] op_sel:[1,0,0] op_sel_hi:[1,1,1] neg_lo:[1,0,0] neg_hi:[1,0,0]
    v_pk_fma_f32 v[120:121], v[26:27], v[120:121], v[44:45] op_sel:[0,0,0] op_sel_hi:[0,1,1]
    s_add_u32 m0, s44, 7168
    s_nop 0
    buffer_load_dwordx4 v231, s[96:99], s69 offen lds
    v_pk_mul_f32 v[46:47], v[26:27], v[90:91] op_sel:[1,0] op_sel_hi:[1,1]
    v_pk_mul_f32 v[90:91], v[26:27], v[90:91] op_sel:[0,0] op_sel_hi:[0,1]
    v_pk_fma_f32 v[90:91], v[26:27], v[122:123], v[90:91] op_sel:[1,0,0] op_sel_hi:[1,1,1] neg_lo:[1,0,0] neg_hi:[1,0,0]
    v_pk_fma_f32 v[122:123], v[26:27], v[122:123], v[46:47] op_sel:[0,0,0] op_sel_hi:[0,1,1]
    v_pk_mul_f32 v[44:45], v[26:27], v[92:93] op_sel:[1,0] op_sel_hi:[1,1]
    v_pk_mul_f32 v[92:93], v[26:27], v[92:93] op_sel:[0,0] op_sel_hi:[0,1]
    v_pk_fma_f32 v[92:93], v[26:27], v[124:125], v[92:93] op_sel:[1,0,0] op_sel_hi:[1,1,1] neg_lo:[1,0,0] neg_hi:[1,0,0]
    v_pk_fma_f32 v[124:125], v[26:27], v[124:125], v[44:45] op_sel:[0,0,0] op_sel_hi:[0,1,1]
    v_pk_mul_f32 v[46:47], v[26:27], v[94:95] op_sel:[1,0] op_sel_hi:[1,1]
    v_pk_mul_f32 v[94:95], v[26:27], v[94:95] op_sel:[0,0] op_sel_hi:[0,1]
    v_pk_fma_f32 v[94:95], v[26:27], v[126:127], v[94:95] op_sel:[1,0,0] op_sel_hi:[1,1,1] neg_lo:[1,0,0] neg_hi:[1,0,0]
    v_pk_fma_f32 v[126:127], v[26:27], v[126:127], v[46:47] op_sel:[0,0,0] op_sel_hi:[0,1,1]
    buffer_load_dwordx4 v[156:159], v199, s[64:67], 0 offen offset:3072 sc1
    buffer_load_dwordx4 v[152:155], v199, s[64:67], 0 offen offset:2048 sc1
    buffer_load_dwordx4 v[148:151], v199, s[64:67], 0 offen offset:1024 sc1
    buffer_load_dwordx4 v[144:147], v199, s[64:67], 0 offen offset:0 sc1
    buffer_load_dwordx4 v[140:143], v198, s[64:67], 0 offen offset:3072 sc1
    buffer_load_dwordx4 v[136:139], v198, s[64:67], 0 offen offset:2048 sc1
    buffer_load_dwordx4 v[132:135], v198, s[64:67], 0 offen offset:1024 sc1
    buffer_load_dwordx4 v[128:131], v198, s[64:67], 0 offen offset:0 sc1
    s_add_u32 m0, s44, 32768
    s_nop 0
    buffer_load_dwordx4 v224, s[96:99], s18 offen lds
    s_add_u32 m0, s44, 33792
    s_nop 0
    buffer_load_dwordx4 v225, s[96:99], s18 offen lds
    s_add_u32 m0, s44, 34816
    s_nop 0
    buffer_load_dwordx4 v226, s[96:99], s18 offen lds
    s_add_u32 m0, s44, 35840
    s_nop 0
    buffer_load_dwordx4 v227, s[96:99], s18 offen lds
    s_add_u32 m0, s44, 36864
    s_nop 0
    buffer_load_dwordx4 v228, s[96:99], s18 offen lds
    s_add_u32 m0, s44, 37888
    s_nop 0
    buffer_load_dwordx4 v229, s[96:99], s18 offen lds
    s_add_u32 m0, s44, 38912
    s_nop 0
    buffer_load_dwordx4 v230, s[96:99], s18 offen lds
    s_add_u32 m0, s44, 39936
    s_nop 0
    buffer_load_dwordx4 v231, s[96:99], s18 offen lds
    s_mov_b32 s59, 262144
    s_waitcnt vmcnt(8)
    v_xor_b32_e64 v6, v129, v176
    v_xor_b32 v5, v131, v176
    v_bitop3_b32 v6, v133, v177, v6 bitop3:0xbe
    v_bitop3_b32 v5, v135, v177, v5 bitop3:0xbe
    v_bitop3_b32 v6, v137, v178, v6 bitop3:0xbe
    v_bitop3_b32 v5, v139, v178, v5 bitop3:0xbe
    v_bitop3_b32 v6, v141, v179, v6 bitop3:0xbe
    v_bitop3_b32 v5, v143, v179, v5 bitop3:0xbe
    v_bitop3_b32 v6, v145, v180, v6 bitop3:0xbe
    v_bitop3_b32 v5, v147, v180, v5 bitop3:0xbe
    v_bitop3_b32 v6, v149, v181, v6 bitop3:0xbe
    v_bitop3_b32 v5, v151, v181, v5 bitop3:0xbe
    v_bitop3_b32 v6, v153, v182, v6 bitop3:0xbe
    v_bitop3_b32 v5, v155, v182, v5 bitop3:0xbe
    v_bitop3_b32 v6, v157, v183, v6 bitop3:0xbe
    v_bitop3_b32 v5, v159, v183, v5 bitop3:0xbe
    v_or_b32 v6, v6, v5
    v_cmp_ne_u32_e64 vcc, 0, v6
    s_cbranch_vccnz Lpoll_12
Lpolld_13:
    v_fma_f32 v152, v32, v156, v152
    v_fma_f32 v154, v32, v158, v154
    v_fma_f32 v152, -v33, v158, v152
    v_fma_f32 v154, v33, v156, v154
    v_fma_f32 v148, v32, v152, v148
    v_fma_f32 v150, v32, v154, v150
    v_fma_f32 v148, -v33, v154, v148
    v_fma_f32 v150, v33, v152, v150
    v_fma_f32 v144, v32, v148, v144
    v_fma_f32 v146, v32, v150, v146
    v_fma_f32 v144, -v33, v150, v144
    v_fma_f32 v146, v33, v148, v146
    v_fma_f32 v140, v32, v144, v140
    v_fma_f32 v142, v32, v146, v142
    v_fma_f32 v140, -v33, v146, v140
    v_fma_f32 v142, v33, v144, v142
    v_fma_f32 v136, v32, v140, v136
    v_fma_f32 v138, v32, v142, v138
    v_fma_f32 v136, -v33, v142, v136
    v_fma_f32 v138, v33, v140, v138
    v_fma_f32 v132, v32, v136, v132
    v_fma_f32 v134, v32, v138, v134
    v_fma_f32 v132, -v33, v138, v132
    v_fma_f32 v134, v33, v136, v134
    v_fma_f32 v128, v32, v132, v128
    v_fma_f32 v130, v32, v134, v130
    v_fma_f32 v128, -v33, v134, v128
    v_fma_f32 v130, v33, v132, v130
    v_mov_b32 v129, v130
    v_mov_b32 v131, v130
    v_mov_b32 v130, v128
    v_cmp_ne_u32 vcc, s23, v196
    s_nop 0
    s_or_b32 s23, vcc_lo, vcc_hi
    v_permlane32_swap_b32 v128, v130
    v_permlane32_swap_b32 v129, v131
    v_pk_fma_f32 v[128:129], v[34:35], v[130:131], v[128:129] op_sel:[0,0,0] op_sel_hi:[0,1,1]
    v_pk_fma_f32 v[128:129], v[34:35], v[130:131], v[128:129] op_sel:[1,1,0] op_sel_hi:[1,0,1] neg_lo:[1,0,0]
    v_pk_fma_f32 v[56:57], v[128:129], v[36:37], v[56:57] op_sel:[0,0,0] op_sel_hi:[0,1,1]
    v_pk_fma_f32 v[58:59], v[128:129], v[38:39], v[58:59] op_sel:[0,0,0] op_sel_hi:[0,1,1]
    v_pk_fma_f32 v[56:57], v[128:129], v[38:39], v[56:57] op_sel:[1,0,0] op_sel_hi:[1,1,1] neg_lo:[1,0,0] neg_hi:[1,0,0]
    v_pk_fma_f32 v[58:59], v[128:129], v[36:37], v[58:59] op_sel:[1,0,0] op_sel_hi:[1,1,1]
    v_xor_b32_e64 v6, 16, v187
    v_xor_b32 v5, 32, v188
    v_mov_b32 v4, s16
    v_pk_fma_f32 v[96:97], v[24:25], v[56:57], v[96:97] op_sel:[1,0,0] op_sel_hi:[1,1,1]
    v_pk_fma_f32 v[64:65], v[24:25], v[58:59], v[64:65] op_sel:[1,0,0] op_sel_hi:[1,1,1] neg_lo:[1,0,0] neg_hi:[1,0,0]
    v_pk_fma_f32 v[64:65], v[24:25], v[56:57], v[64:65] op_sel:[0,0,0] op_sel_hi:[0,1,1]
    v_pk_fma_f32 v[96:97], v[24:25], v[58:59], v[96:97] op_sel:[0,0,0] op_sel_hi:[0,1,1]
    v_pk_fma_f32 v[98:99], v[24:25], v[64:65], v[98:99] op_sel:[1,0,0] op_sel_hi:[1,1,1]
    v_pk_fma_f32 v[66:67], v[24:25], v[96:97], v[66:67] op_sel:[1,0,0] op_sel_hi:[1,1,1] neg_lo:[1,0,0] neg_hi:[1,0,0]
    v_pk_fma_f32 v[66:67], v[24:25], v[64:65], v[66:67] op_sel:[0,0,0] op_sel_hi:[0,1,1]
    v_pk_fma_f32 v[98:99], v[24:25], v[96:97], v[98:99] op_sel:[0,0,0] op_sel_hi:[0,1,1]
    v_pk_fma_f32 v[100:101], v[24:25], v[66:67], v[100:101] op_sel:[1,0,0] op_sel_hi:[1,1,1]
    v_pk_fma_f32 v[68:69], v[24:25], v[98:99], v[68:69] op_sel:[1,0,0] op_sel_hi:[1,1,1] neg_lo:[1,0,0] neg_hi:[1,0,0]
    v_pk_fma_f32 v[68:69], v[24:25], v[66:67], v[68:69] op_sel:[0,0,0] op_sel_hi:[0,1,1]
    v_pk_fma_f32 v[100:101], v[24:25], v[98:99], v[100:101] op_sel:[0,0,0] op_sel_hi:[0,1,1]
    v_pk_fma_f32 v[102:103], v[24:25], v[68:69], v[102:103] op_sel:[1,0,0] op_sel_hi:[1,1,1]
    v_pk_fma_f32 v[70:71], v[24:25], v[100:101], v[70:71] op_sel:[1,0,0] op_sel_hi:[1,1,1] neg_lo:[1,0,0] neg_hi:[1,0,0]
    v_pk_fma_f32 v[70:71], v[24:25], v[68:69], v[70:71] op_sel:[0,0,0] op_sel_hi:[0,1,1]
    v_pk_fma_f32 v[102:103], v[24:25], v[100:101], v[102:103] op_sel:[0,0,0] op_sel_hi:[0,1,1]
    v_pk_fma_f32 v[104:105], v[24:25], v[70:71], v[104:105] op_sel:[1,0,0] op_sel_hi:[1,1,1]
    v_pk_fma_f32 v[72:73], v[24:25], v[102:103], v[72:73] op_sel:[1,0,0] op_sel_hi:[1,1,1] neg_lo:[1,0,0] neg_hi:[1,0,0]
    v_pk_fma_f32 v[72:73], v[24:25], v[70:71], v[72:73] op_sel:[0,0,0] op_sel_hi:[0,1,1]
    v_pk_fma_f32 v[104:105], v[24:25], v[102:103], v[104:105] op_sel:[0,0,0] op_sel_hi:[0,1,1]
    v_pk_fma_f32 v[106:107], v[24:25], v[72:73], v[106:107] op_sel:[1,0,0] op_sel_hi:[1,1,1]
    v_pk_fma_f32 v[74:75], v[24:25], v[104:105], v[74:75] op_sel:[1,0,0] op_sel_hi:[1,1,1] neg_lo:[1,0,0] neg_hi:[1,0,0]
    v_pk_fma_f32 v[74:75], v[24:25], v[72:73], v[74:75] op_sel:[0,0,0] op_sel_hi:[0,1,1]
    v_pk_fma_f32 v[106:107], v[24:25], v[104:105], v[106:107] op_sel:[0,0,0] op_sel_hi:[0,1,1]
    v_pk_fma_f32 v[108:109], v[24:25], v[74:75], v[108:109] op_sel:[1,0,0] op_sel_hi:[1,1,1]
    v_pk_fma_f32 v[76:77], v[24:25], v[106:107], v[76:77] op_sel:[1,0,0] op_sel_hi:[1,1,1] neg_lo:[1,0,0] neg_hi:[1,0,0]
    v_pk_fma_f32 v[76:77], v[24:25], v[74:75], v[76:77] op_sel:[0,0,0] op_sel_hi:[0,1,1]
    v_pk_fma_f32 v[108:109], v[24:25], v[106:107], v[108:109] op_sel:[0,0,0] op_sel_hi:[0,1,1]
    v_pk_fma_f32 v[110:111], v[24:25], v[76:77], v[110:111] op_sel:[1,0,0] op_sel_hi:[1,1,1]
    v_pk_fma_f32 v[78:79], v[24:25], v[108:109], v[78:79] op_sel:[1,0,0] op_sel_hi:[1,1,1] neg_lo:[1,0,0] neg_hi:[1,0,0]
    v_pk_fma_f32 v[78:79], v[24:25], v[76:77], v[78:79] op_sel:[0,0,0] op_sel_hi:[0,1,1]
    v_pk_fma_f32 v[110:111], v[24:25], v[108:109], v[110:111] op_sel:[0,0,0] op_sel_hi:[0,1,1]
    v_cvt_pk_bf16_f32 v128, v64, v66
    v_cvt_pk_bf16_f32 v129, v68, v70
    v_cvt_pk_bf16_f32 v130, v72, v74
    v_cvt_pk_bf16_f32 v131, v76, v78
    ds_write_b128 v187, v[128:131] offset:0
    v_cvt_pk_bf16_f32 v132, v65, v67
    v_cvt_pk_bf16_f32 v133, v69, v71
    v_cvt_pk_bf16_f32 v134, v73, v75
    v_cvt_pk_bf16_f32 v135, v77, v79
    ds_write_b128 v6, v[132:135] offset:0
    v_cvt_pk_bf16_f32 v136, -v96, -v98
    v_cvt_pk_bf16_f32 v137, -v100, -v102
    v_cvt_pk_bf16_f32 v138, -v104, -v106
    v_cvt_pk_bf16_f32 v139, -v108, -v110
    ds_write_b128 v187, v[136:139] offset:2048
    v_cvt_pk_bf16_f32 v140, -v97, -v99
    v_cvt_pk_bf16_f32 v141, -v101, -v103
    v_cvt_pk_bf16_f32 v142, -v105, -v107
    v_cvt_pk_bf16_f32 v143, -v109, -v111
    ds_write_b128 v6, v[140:143] offset:2048
    ds_read_b64_tr_b16 v[144:145], v188 offset:0
    ds_read_b64_tr_b16 v[146:147], v5 offset:256
    ds_read_b64_tr_b16 v[148:149], v188 offset:1024
    ds_read_b64_tr_b16 v[150:151], v5 offset:1280
    ds_read_b64_tr_b16 v[152:153], v188 offset:2048
    ds_read_b64_tr_b16 v[154:155], v5 offset:2304
    ds_read_b64_tr_b16 v[156:157], v188 offset:3072
    ds_read_b64_tr_b16 v[158:159], v5 offset:3328
    v_pk_fma_f32 v[112:113], v[24:25], v[78:79], v[112:113] op_sel:[1,0,0] op_sel_hi:[1,1,1]
    v_pk_fma_f32 v[80:81], v[24:25], v[110:111], v[80:81] op_sel:[1,0,0] op_sel_hi:[1,1,1] neg_lo:[1,0,0] neg_hi:[1,0,0]
    v_pk_fma_f32 v[80:81], v[24:25], v[78:79], v[80:81] op_sel:[0,0,0] op_sel_hi:[0,1,1]
    v_pk_fma_f32 v[112:113], v[24:25], v[110:111], v[112:113] op_sel:[0,0,0] op_sel_hi:[0,1,1]
    v_pk_fma_f32 v[114:115], v[24:25], v[80:81], v[114:115] op_sel:[1,0,0] op_sel_hi:[1,1,1]
    v_pk_fma_f32 v[82:83], v[24:25], v[112:113], v[82:83] op_sel:[1,0,0] op_sel_hi:[1,1,1] neg_lo:[1,0,0] neg_hi:[1,0,0]
    v_pk_fma_f32 v[82:83], v[24:25], v[80:81], v[82:83] op_sel:[0,0,0] op_sel_hi:[0,1,1]
    v_pk_fma_f32 v[114:115], v[24:25], v[112:113], v[114:115] op_sel:[0,0,0] op_sel_hi:[0,1,1]
    v_pk_fma_f32 v[116:117], v[24:25], v[82:83], v[116:117] op_sel:[1,0,0] op_sel_hi:[1,1,1]
    v_pk_fma_f32 v[84:85], v[24:25], v[114:115], v[84:85] op_sel:[1,0,0] op_sel_hi:[1,1,1] neg_lo:[1,0,0] neg_hi:[1,0,0]
    v_pk_fma_f32 v[84:85], v[24:25], v[82:83], v[84:85] op_sel:[0,0,0] op_sel_hi:[0,1,1]
    v_pk_fma_f32 v[116:117], v[24:25], v[114:115], v[116:117] op_sel:[0,0,0] op_sel_hi:[0,1,1]
    v_pk_fma_f32 v[118:119], v[24:25], v[84:85], v[118:119] op_sel:[1,0,0] op_sel_hi:[1,1,1]
    v_pk_fma_f32 v[86:87], v[24:25], v[116:117], v[86:87] op_sel:[1,0,0] op_sel_hi:[1,1,1] neg_lo:[1,0,0] neg_hi:[1,0,0]
    v_pk_fma_f32 v[86:87], v[24:25], v[84:85], v[86:87] op_sel:[0,0,0] op_sel_hi:[0,1,1]
    v_pk_fma_f32 v[118:119], v[24:25], v[116:117], v[118:119] op_sel:[0,0,0] op_sel_hi:[0,1,1]
    v_pk_fma_f32 v[120:121], v[24:25], v[86:87], v[120:121] op_sel:[1,0,0] op_sel_hi:[1,1,1]
    v_pk_fma_f32 v[88:89], v[24:25], v[118:119], v[88:89] op_sel:[1,0,0] op_sel_hi:[1,1,1] neg_lo:[1,0,0] neg_hi:[1,0,0]
    v_pk_fma_f32 v[88:89], v[24:25], v[86:87], v[88:89] op_sel:[0,0,0] op_sel_hi:[0,1,1]
    v_pk_fma_f32 v[120:121], v[24:25], v[118:119], v[120:121] op_sel:[0,0,0] op_sel_hi:[0,1,1]
    s_add_u32 s53, s15, 0
    s_waitcnt lgkmcnt(6)
    buffer_store_dwordx4 v[144:147], v189, s[36:39], s53 offen offset:0 sc1
    v_pk_fma_f32 v[122:123], v[24:25], v[88:89], v[122:123] op_sel:[1,0,0] op_sel_hi:[1,1,1]
    v_pk_fma_f32 v[90:91], v[24:25], v[120:121], v[90:91] op_sel:[1,0,0] op_sel_hi:[1,1,1] neg_lo:[1,0,0] neg_hi:[1,0,0]
    v_pk_fma_f32 v[90:91], v[24:25], v[88:89], v[90:91] op_sel:[0,0,0] op_sel_hi:[0,1,1]
    v_pk_fma_f32 v[122:123], v[24:25], v[120:121], v[122:123] op_sel:[0,0,0] op_sel_hi:[0,1,1]
    s_add_u32 s53, s15, 0
    s_waitcnt lgkmcnt(4)
    buffer_store_dwordx4 v[148:151], v189, s[36:39], s53 offen offset:1024 sc1
    v_pk_fma_f32 v[124:125], v[24:25], v[90:91], v[124:125] op_sel:[1,0,0] op_sel_hi:[1,1,1]
    v_pk_fma_f32 v[92:93], v[24:25], v[122:123], v[92:93] op_sel:[1,0,0] op_sel_hi:[1,1,1] neg_lo:[1,0,0] neg_hi:[1,0,0]
    v_pk_fma_f32 v[92:93], v[24:25], v[90:91], v[92:93] op_sel:[0,0,0] op_sel_hi:[0,1,1]
    v_pk_fma_f32 v[124:125], v[24:25], v[122:123], v[124:125] op_sel:[0,0,0] op_sel_hi:[0,1,1]
    s_add_u32 s53, s15, 32768
    s_waitcnt lgkmcnt(2)
    buffer_store_dwordx4 v[152:155], v189, s[36:39], s53 offen offset:0 sc1
    v_pk_fma_f32 v[126:127], v[24:25], v[92:93], v[126:127] op_sel:[1,0,0] op_sel_hi:[1,1,1]
    v_pk_fma_f32 v[94:95], v[24:25], v[124:125], v[94:95] op_sel:[1,0,0] op_sel_hi:[1,1,1] neg_lo:[1,0,0] neg_hi:[1,0,0]
    v_pk_fma_f32 v[94:95], v[24:25], v[92:93], v[94:95] op_sel:[0,0,0] op_sel_hi:[0,1,1]
    v_pk_fma_f32 v[126:127], v[24:25], v[124:125], v[126:127] op_sel:[0,0,0] op_sel_hi:[0,1,1]
    s_add_u32 s53, s15, 32768
    s_waitcnt lgkmcnt(0)
    buffer_store_dwordx4 v[156:159], v189, s[36:39], s53 offen offset:1024 sc1
    v_cvt_pk_bf16_f32 v128, v80, v82
    v_cvt_pk_bf16_f32 v129, v84, v86
    v_cvt_pk_bf16_f32 v130, v88, v90
    v_cvt_pk_bf16_f32 v131, v92, v94
    ds_write_b128 v187, v[128:131] offset:4096
    v_cvt_pk_bf16_f32 v132, v81, v83
    v_cvt_pk_bf16_f32 v133, v85, v87
    v_cvt_pk_bf16_f32 v134, v89, v91
    v_cvt_pk_bf16_f32 v135, v93, v95
    ds_write_b128 v6, v[132:135] offset:4096
    v_cvt_pk_bf16_f32 v136, -v112, -v114
    v_cvt_pk_bf16_f32 v137, -v116, -v118
    v_cvt_pk_bf16_f32 v138, -v120, -v122
    v_cvt_pk_bf16_f32 v139, -v124, -v126
    ds_write_b128 v187, v[136:139] offset:6144
    v_cvt_pk_bf16_f32 v140, -v113, -v115
    v_cvt_pk_bf16_f32 v141, -v117, -v119
    v_cvt_pk_bf16_f32 v142, -v121, -v123
    v_cvt_pk_bf16_f32 v143, -v125, -v127
    ds_write_b128 v6, v[140:143] offset:6144
    ds_read_b64_tr_b16 v[160:161], v188 offset:4096
    ds_read_b64_tr_b16 v[162:163], v5 offset:4352
    ds_read_b64_tr_b16 v[164:165], v188 offset:5120
    ds_read_b64_tr_b16 v[166:167], v5 offset:5376
    ds_read_b64_tr_b16 v[168:169], v188 offset:6144
    ds_read_b64_tr_b16 v[170:171], v5 offset:6400
    ds_read_b64_tr_b16 v[172:173], v188 offset:7168
    ds_read_b64_tr_b16 v[174:175], v5 offset:7424
    s_add_u32 s53, s15, 65536
    s_waitcnt lgkmcnt(6)
    buffer_store_dwordx4 v[160:163], v189, s[36:39], s53 offen offset:0 sc1
    s_add_u32 s53, s15, 65536
    s_waitcnt lgkmcnt(4)
    buffer_store_dwordx4 v[164:167], v189, s[36:39], s53 offen offset:1024 sc1
    s_add_u32 s53, s15, 98304
    s_waitcnt lgkmcnt(2)
    buffer_store_dwordx4 v[168:171], v189, s[36:39], s53 offen offset:0 sc1
    s_add_u32 s53, s15, 98304
    s_waitcnt lgkmcnt(0)
    buffer_store_dwordx4 v[172:175], v189, s[36:39], s53 offen offset:1024 sc1
    global_load_dword v197, v193, s[90:91]
    s_mov_b32 s49, 0
    buffer_load_dword v208, v191, s[24:27], s49 offen offset:0
    s_mov_b32 s49, 0
    buffer_load_dword v209, v191, s[24:27], s49 offen offset:1024
    s_mov_b32 s49, 0
    buffer_load_dword v210, v191, s[24:27], s49 offen offset:2048
    s_mov_b32 s49, 0
    buffer_load_dword v211, v191, s[24:27], s49 offen offset:3072
    s_mov_b32 s49, 16384
    buffer_load_dword v212, v191, s[24:27], s49 offen offset:0
    s_mov_b32 s49, 16384
    buffer_load_dword v213, v191, s[24:27], s49 offen offset:1024
    s_mov_b32 s49, 16384
    buffer_load_dword v214, v191, s[24:27], s49 offen offset:2048
    s_mov_b32 s49, 16384
    buffer_load_dword v215, v191, s[24:27], s49 offen offset:3072
    s_mov_b32 s49, 32768
    buffer_load_dword v216, v191, s[24:27], s49 offen offset:0
    s_mov_b32 s49, 32768
    buffer_load_dword v217, v191, s[24:27], s49 offen offset:1024
    s_mov_b32 s49, 32768
    buffer_load_dword v218, v191, s[24:27], s49 offen offset:2048
    s_mov_b32 s49, 32768
    buffer_load_dword v219, v191, s[24:27], s49 offen offset:3072
    s_mov_b32 s49, 49152
    buffer_load_dword v220, v191, s[24:27], s49 offen offset:0
    s_mov_b32 s49, 49152
    buffer_load_dword v221, v191, s[24:27], s49 offen offset:1024
    s_mov_b32 s49, 49152
    buffer_load_dword v222, v191, s[24:27], s49 offen offset:2048
    s_waitcnt vmcnt(20)
    s_mov_b64 exec, 1
    s_cmp_lg_u32 s23, 0
    s_cbranch_scc1 Lfs_15
    buffer_store_dword v194, v4, s[36:39], s13 offen
    s_branch Lfe_16
Lfs_15:
    buffer_store_dword v194, v4, s[36:39], s13 offen sc1
Lfe_16:
    s_mov_b64 exec, -1
    s_waitcnt vmcnt(17)
    s_mov_b64 exec, 1
    s_cmp_lg_u32 s23, 0
    s_cbranch_scc1 Lfs_17
    buffer_store_dword v194, v4, s[36:39], s14 offen
    s_branch Lfe_18
Lfs_17:
    buffer_store_dword v194, v4, s[36:39], s14 offen sc1
Lfe_18:
    s_mov_b64 exec, -1
    s_mov_b32 s49, 49152
    buffer_load_dword v223, v191, s[24:27], s49 offen offset:3072
    s_barrier
    s_lshl_b32 s48, s63, 7
    v_subrev_u32 v2, s48, v188
    v_xor_b32 v3, 32, v2
    ds_read_b64_tr_b16 a[0:1], v2 offset:0
    ds_read_b64_tr_b16 a[2:3], v3 offset:256
    ds_read_b64_tr_b16 a[4:5], v2 offset:1024
    ds_read_b64_tr_b16 a[6:7], v3 offset:1280
    ds_read_b64_tr_b16 a[8:9], v2 offset:8192
    ds_read_b64_tr_b16 a[10:11], v3 offset:8448
    ds_read_b64_tr_b16 a[12:13], v2 offset:9216
    ds_read_b64_tr_b16 a[14:15], v3 offset:9472
    ds_read_b64_tr_b16 a[128:129], v2 offset:2048
    ds_read_b64_tr_b16 a[130:131], v3 offset:2304
    ds_read_b64_tr_b16 a[132:133], v2 offset:3072
    ds_read_b64_tr_b16 a[134:135], v3 offset:3328
    ds_read_b64_tr_b16 a[136:137], v2 offset:10240
    ds_read_b64_tr_b16 a[138:139], v3 offset:10496
    ds_read_b64_tr_b16 a[140:141], v2 offset:11264
    ds_read_b64_tr_b16 a[142:143], v3 offset:11520
    ds_read_b128 v[96:99], v200 offset:0
    ds_read_b128 v[100:103], v200 offset:32768
    ds_read_b128 v[104:107], v201 offset:0
    ds_read_b128 v[108:111], v201 offset:32768
    ds_read_b128 v[112:115], v202 offset:0
    ds_read_b128 v[116:119], v202 offset:32768
    s_mov_b32 s59, 262144
Lpf_19:
    buffer_load_dword v5, v190, s[36:39], s12 offen sc1
    s_waitcnt vmcnt(0)
    v_cmp_ne_u32 vcc, s3, v5
    s_cbranch_vccz Lpfd_20
    s_sub_u32 s59, s59, 1
    s_cmp_eq_u32 s59, 0
    s_cbranch_scc1 Lpfd_20
    s_branch Lpf_19
Lpfd_20:
    s_mov_b32 s57, 4096
    s_cmp_eq_u32 s51, 1
    s_cselect_b32 s57, 0, s57
    s_add_u32 s57, s57, s68
    buffer_load_dwordx4 a[16:19], v189, s[36:39], s57 offen offset:0 sc1
    buffer_load_dwordx4 a[20:23], v189, s[36:39], s57 offen offset:1024 sc1
    buffer_load_dwordx4 a[24:27], v189, s[36:39], s57 offen offset:2048 sc1
    buffer_load_dwordx4 a[28:31], v189, s[36:39], s57 offen offset:3072 sc1
    s_mov_b32 s57, 8192
    s_cmp_eq_u32 s51, 2
    s_cselect_b32 s57, 0, s57
    s_add_u32 s57, s57, s68
    buffer_load_dwordx4 a[32:35], v189, s[36:39], s57 offen offset:0 sc1
    buffer_load_dwordx4 a[36:39], v189, s[36:39], s57 offen offset:1024 sc1
    buffer_load_dwordx4 a[40:43], v189, s[36:39], s57 offen offset:2048 sc1
    buffer_load_dwordx4 a[44:47], v189, s[36:39], s57 offen offset:3072 sc1
    s_mov_b32 s57, 12288
    s_cmp_eq_u32 s51, 3
    s_cselect_b32 s57, 0, s57
    s_add_u32 s57, s57, s68
    buffer_load_dwordx4 a[48:51], v189, s[36:39], s57 offen offset:0 sc1
    buffer_load_dwordx4 a[52:55], v189, s[36:39], s57 offen offset:1024 sc1
    buffer_load_dwordx4 a[56:59], v189, s[36:39], s57 offen offset:2048 sc1
    buffer_load_dwordx4 a[60:63], v189, s[36:39], s57 offen offset:3072 sc1
    s_waitcnt lgkmcnt(4)
    v_mfma_f32_32x32x16_bf16 v[64:79], a[0:3], v[96:99], 0
    ds_read_b128 v[120:123], v203 offset:0
    v_lshlrev_b32 v28, 16, v197
    v_and_b32 v29, 0xffff0000, v197
    v_mfma_f32_32x32x16_bf16 v[80:95], a[0:3], v[100:103], 0
    ds_read_b128 v[124:127], v203 offset:32768
    v_lshlrev_b32 v224, 16, v208
    v_and_b32 v225, 0xffff0000, v208
    v_mul_f32 v224, v224, v28
    s_waitcnt lgkmcnt(4)
    v_mfma_f32_32x32x16_bf16 v[64:79], a[4:7], v[104:107], v[64:79]
    ds_read_b128 v[96:99], v204 offset:0
    v_mul_f32 v225, v225, v29
    v_cvt_pk_bf16_f32 v225, v224, v225
    v_mfma_f32_32x32x16_bf16 v[80:95], a[4:7], v[108:111], v[80:95]
    ds_read_b128 v[100:103], v204 offset:32768
    v_lshlrev_b32 v224, 16, v225
    v_and_b32 v225, 0xffff0000, v225
    s_waitcnt lgkmcnt(4)
    v_mfma_f32_32x32x16_bf16 v[64:79], a[8:11], v[112:115], v[64:79]
    ds_read_b128 v[104:107], v205 offset:0
    v_lshlrev_b32 v226, 16, v209
    v_and_b32 v227, 0xffff0000, v209
    v_mul_f32 v226, v226, v28
    v_mfma_f32_32x32x16_bf16 v[80:95], a[8:11], v[116:119], v[80:95]
    ds_read_b128 v[108:111], v205 offset:32768
    v_mul_f32 v227, v227, v29
    v_cvt_pk_bf16_f32 v227, v226, v227
    s_waitcnt lgkmcnt(4)
    v_mfma_f32_32x32x16_bf16 v[64:79], a[12:15], v[120:123], v[64:79]
    ds_read_b128 v[112:115], v206 offset:0
    v_lshlrev_b32_e64 v226, 16, v227
    v_and_b32 v227, 0xffff0000, v227
    v_mfma_f32_32x32x16_bf16 v[80:95], a[12:15], v[124:127], v[80:95]
    ds_read_b128 v[116:119], v206 offset:32768
    v_lshlrev_b32 v228, 16, v210
    v_and_b32 v229, 0xffff0000, v210
    v_mul_f32 v228, v228, v28
    s_waitcnt vmcnt(11) lgkmcnt(4)
    v_mfma_f32_32x32x16_bf16 v[64:79], a[16:19], v[96:99], v[64:79]
    ds_read_b128 v[120:123], v207 offset:0
    s_mov_b32 s57, 16384
    s_cmp_eq_u32 s51, 4
    s_cselect_b32 s57, 0, s57
    s_add_u32 s57, s57, s68
    buffer_load_dwordx4 a[64:67], v189, s[36:39], s57 offen offset:0 sc1
    v_mfma_f32_32x32x16_bf16 v[80:95], a[16:19], v[100:103], v[80:95]
    ds_read_b128 v[124:127], v207 offset:32768
    v_mul_f32 v229, v229, v29
    v_cvt_pk_bf16_f32 v229, v228, v229
    s_waitcnt vmcnt(11) lgkmcnt(4)
    v_mfma_f32_32x32x16_bf16 v[64:79], a[20:23], v[104:107], v[64:79]
    ds_read_b128 v[96:99], v200 offset:256
    buffer_load_dwordx4 a[68:71], v189, s[36:39], s57 offen offset:1024 sc1
    v_mfma_f32_32x32x16_bf16 v[80:95], a[20:23], v[108:111], v[80:95]
    ds_read_b128 v[100:103], v200 offset:33024
    v_lshlrev_b32 v228, 16, v229
    v_and_b32 v229, 0xffff0000, v229
    s_waitcnt vmcnt(11) lgkmcnt(4)
    v_mfma_f32_32x32x16_bf16 v[64:79], a[24:27], v[112:115], v[64:79]
    ds_read_b128 v[104:107], v201 offset:256
    buffer_load_dwordx4 a[72:75], v189, s[36:39], s57 offen offset:2048 sc1
    v_mfma_f32_32x32x16_bf16 v[80:95], a[24:27], v[116:119], v[80:95]
    ds_read_b128 v[108:111], v201 offset:33024
    v_lshlrev_b32_e64 v230, 16, v211
    v_and_b32 v231, 0xffff0000, v211
    v_mul_f32 v230, v230, v28
    s_waitcnt vmcnt(11) lgkmcnt(4)
    v_mfma_f32_32x32x16_bf16 v[64:79], a[28:31], v[120:123], v[64:79]
    ds_read_b128 v[112:115], v202 offset:256
    buffer_load_dwordx4 a[76:79], v189, s[36:39], s57 offen offset:3072 sc1
    v_mfma_f32_32x32x16_bf16 v[80:95], a[28:31], v[124:127], v[80:95]
    ds_read_b128 v[116:119], v202 offset:33024
    v_mul_f32 v231, v231, v29
    v_cvt_pk_bf16_f32 v231, v230, v231
    s_waitcnt vmcnt(11) lgkmcnt(4)
    v_mfma_f32_32x32x16_bf16 v[64:79], a[32:35], v[96:99], v[64:79]
    ds_read_b128 v[120:123], v203 offset:256
    s_mov_b32 s57, 20480
    s_cmp_eq_u32 s51, 5
    s_cselect_b32 s57, 0, s57
    s_add_u32 s57, s57, s68
    buffer_load_dwordx4 a[80:83], v189, s[36:39], s57 offen offset:0 sc1
    v_mfma_f32_32x32x16_bf16 v[80:95], a[32:35], v[100:103], v[80:95]
    ds_read_b128 v[124:127], v203 offset:33024
    v_lshlrev_b32 v230, 16, v231
    v_and_b32 v231, 0xffff0000, v231
    s_waitcnt vmcnt(11) lgkmcnt(4)
    v_mfma_f32_32x32x16_bf16 v[64:79], a[36:39], v[104:107], v[64:79]
    ds_read_b128 v[96:99], v204 offset:256
    buffer_load_dwordx4 a[84:87], v189, s[36:39], s57 offen offset:1024 sc1
    v_mfma_f32_32x32x16_bf16 v[80:95], a[36:39], v[108:111], v[80:95]
    ds_read_b128 v[100:103], v204 offset:33024
    v_lshlrev_b32 v232, 16, v212
    v_and_b32 v233, 0xffff0000, v212
    v_mul_f32 v232, v232, v28
    s_waitcnt vmcnt(11) lgkmcnt(4)
    v_mfma_f32_32x32x16_bf16 v[64:79], a[40:43], v[112:115], v[64:79]
    ds_read_b128 v[104:107], v205 offset:256
    buffer_load_dwordx4 a[88:91], v189, s[36:39], s57 offen offset:2048 sc1
    v_mfma_f32_32x32x16_bf16 v[80:95], a[40:43], v[116:119], v[80:95]
    ds_read_b128 v[108:111], v205 offset:33024
    v_mul_f32 v233, v233, v29
    v_cvt_pk_bf16_f32 v233, v232, v233
    s_waitcnt vmcnt(11) lgkmcnt(4)
    v_mfma_f32_32x32x16_bf16 v[64:79], a[44:47], v[120:123], v[64:79]
    ds_read_b128 v[112:115], v206 offset:256
    buffer_load_dwordx4 a[92:95], v189, s[36:39], s57 offen offset:3072 sc1
    v_mfma_f32_32x32x16_bf16 v[80:95], a[44:47], v[124:127], v[80:95]
    ds_read_b128 v[116:119], v206 offset:33024
    v_lshlrev_b32 v232, 16, v233
    v_and_b32 v233, 0xffff0000, v233
    s_waitcnt vmcnt(11) lgkmcnt(4)
    v_mfma_f32_32x32x16_bf16 v[64:79], a[48:51], v[96:99], v[64:79]
    ds_read_b128 v[120:123], v207 offset:256
    s_mov_b32 s57, 24576
    s_cmp_eq_u32 s51, 6
    s_cselect_b32 s57, 0, s57
    s_add_u32 s57, s57, s68
    buffer_load_dwordx4 a[96:99], v189, s[36:39], s57 offen offset:0 sc1
    v_mfma_f32_32x32x16_bf16 v[80:95], a[48:51], v[100:103], v[80:95]
    ds_read_b128 v[124:127], v207 offset:33024
    v_lshlrev_b32 v234, 16, v213
    v_and_b32 v235, 0xffff0000, v213
    v_mul_f32 v234, v234, v28
    s_waitcnt vmcnt(11) lgkmcnt(4)
    v_mfma_f32_32x32x16_bf16 v[64:79], a[52:55], v[104:107], v[64:79]
    ds_read_b128 v[96:99], v200 offset:512
    buffer_load_dwordx4 a[100:103], v189, s[36:39], s57 offen offset:1024 sc1
    v_mfma_f32_32x32x16_bf16 v[80:95], a[52:55], v[108:111], v[80:95]
    ds_read_b128 v[100:103], v200 offset:33280
    v_mul_f32 v235, v235, v29
    v_cvt_pk_bf16_f32 v235, v234, v235
    s_waitcnt vmcnt(11) lgkmcnt(4)
    v_mfma_f32_32x32x16_bf16 v[64:79], a[56:59], v[112:115], v[64:79]
    ds_read_b128 v[104:107], v201 offset:512
    buffer_load_dwordx4 a[104:107], v189, s[36:39], s57 offen offset:2048 sc1
    v_mfma_f32_32x32x16_bf16 v[80:95], a[56:59], v[116:119], v[80:95]
    ds_read_b128 v[108:111], v201 offset:33280
    v_lshlrev_b32 v234, 16, v235
    v_and_b32 v235, 0xffff0000, v235
    s_waitcnt vmcnt(11) lgkmcnt(4)
    v_mfma_f32_32x32x16_bf16 v[64:79], a[60:63], v[120:123], v[64:79]
    ds_read_b128 v[112:115], v202 offset:512
    buffer_load_dwordx4 a[108:111], v189, s[36:39], s57 offen offset:3072 sc1
    v_mfma_f32_32x32x16_bf16 v[80:95], a[60:63], v[124:127], v[80:95]
    ds_read_b128 v[116:119], v202 offset:33280
    v_lshlrev_b32 v236, 16, v214
    v_and_b32 v237, 0xffff0000, v214
    v_mul_f32 v236, v236, v28
    s_waitcnt vmcnt(11) lgkmcnt(4)
    v_mfma_f32_32x32x16_bf16 v[64:79], a[64:67], v[96:99], v[64:79]
    ds_read_b128 v[120:123], v203 offset:512
    s_mov_b32 s57, 28672
    s_cmp_eq_u32 s51, 7
    s_cselect_b32 s57, 0, s57
    s_add_u32 s57, s57, s68
    buffer_load_dwordx4 a[112:115], v189, s[36:39], s57 offen offset:0 sc1
    v_mfma_f32_32x32x16_bf16 v[80:95], a[64:67], v[100:103], v[80:95]
    ds_read_b128 v[124:127], v203 offset:33280
    v_mul_f32 v237, v237, v29
    v_cvt_pk_bf16_f32 v237, v236, v237
    s_waitcnt vmcnt(11) lgkmcnt(4)
    v_mfma_f32_32x32x16_bf16 v[64:79], a[68:71], v[104:107], v[64:79]
    ds_read_b128 v[96:99], v204 offset:512
    buffer_load_dwordx4 a[116:119], v189, s[36:39], s57 offen offset:1024 sc1
    v_mfma_f32_32x32x16_bf16 v[80:95], a[68:71], v[108:111], v[80:95]
    ds_read_b128 v[100:103], v204 offset:33280
    v_lshlrev_b32 v236, 16, v237
    v_and_b32 v237, 0xffff0000, v237
    s_waitcnt vmcnt(11) lgkmcnt(4)
    v_mfma_f32_32x32x16_bf16 v[64:79], a[72:75], v[112:115], v[64:79]
    ds_read_b128 v[104:107], v205 offset:512
    buffer_load_dwordx4 a[120:123], v189, s[36:39], s57 offen offset:2048 sc1
    v_mfma_f32_32x32x16_bf16 v[80:95], a[72:75], v[116:119], v[80:95]
    ds_read_b128 v[108:111], v205 offset:33280
    v_lshlrev_b32 v238, 16, v215
    v_and_b32 v239, 0xffff0000, v215
    s_waitcnt vmcnt(11) lgkmcnt(4)
    v_mfma_f32_32x32x16_bf16 v[64:79], a[76:79], v[120:123], v[64:79]
    ds_read_b128 v[112:115], v206 offset:512
    buffer_load_dwordx4 a[124:127], v189, s[36:39], s57 offen offset:3072 sc1
    v_mfma_f32_32x32x16_bf16 v[80:95], a[76:79], v[124:127], v[80:95]
    ds_read_b128 v[116:119], v206 offset:33280
    v_mul_f32_e64 v238, v238, v28
    v_mul_f32 v239, v239, v29
    v_cvt_pk_bf16_f32 v239, v238, v239
    s_waitcnt vmcnt(11) lgkmcnt(4)
    v_mfma_f32_32x32x16_bf16 v[64:79], a[80:83], v[96:99], v[64:79]
    ds_read_b128 v[120:123], v207 offset:512
    s_mov_b32 s57, 36864
    s_cmp_eq_u32 s51, 1
    s_cselect_b32 s57, 32768, s57
    s_add_u32 s57, s57, s68
    buffer_load_dwordx4 a[144:147], v189, s[36:39], s57 offen offset:0 sc1
    v_mfma_f32_32x32x16_bf16 v[80:95], a[80:83], v[100:103], v[80:95]
    ds_read_b128 v[124:127], v207 offset:33280
    v_lshlrev_b32 v238, 16, v239
    v_and_b32 v239, 0xffff0000, v239
    s_waitcnt vmcnt(11) lgkmcnt(4)
    v_mfma_f32_32x32x16_bf16 v[64:79], a[84:87], v[104:107], v[64:79]
    ds_read_b128 v[96:99], v200 offset:768
    buffer_load_dwordx4 a[148:151], v189, s[36:39], s57 offen offset:1024 sc1
    v_mfma_f32_32x32x16_bf16 v[80:95], a[84:87], v[108:111], v[80:95]
    ds_read_b128 v[100:103], v200 offset:33536
    v_lshlrev_b32 v240, 16, v216
    v_and_b32 v241, 0xffff0000, v216
    s_waitcnt vmcnt(11) lgkmcnt(4)
    v_mfma_f32_32x32x16_bf16 v[64:79], a[88:91], v[112:115], v[64:79]
    ds_read_b128 v[104:107], v201 offset:768
    buffer_load_dwordx4 a[152:155], v189, s[36:39], s57 offen offset:2048 sc1
    v_mfma_f32_32x32x16_bf16 v[80:95], a[88:91], v[116:119], v[80:95]
    ds_read_b128 v[108:111], v201 offset:33536
    v_mul_f32_e64 v240, v240, v28
    v_mul_f32 v241, v241, v29
    v_cvt_pk_bf16_f32 v241, v240, v241
    s_waitcnt vmcnt(11) lgkmcnt(4)
    v_mfma_f32_32x32x16_bf16 v[64:79], a[92:95], v[120:123], v[64:79]
    ds_read_b128 v[112:115], v202 offset:768
    buffer_load_dwordx4 a[156:159], v189, s[36:39], s57 offen offset:3072 sc1
    v_mfma_f32_32x32x16_bf16 v[80:95], a[92:95], v[124:127], v[80:95]
    ds_read_b128 v[116:119], v202 offset:33536
    v_lshlrev_b32 v240, 16, v241
    v_and_b32 v241, 0xffff0000, v241
    s_waitcnt vmcnt(11) lgkmcnt(4)
    v_mfma_f32_32x32x16_bf16 v[64:79], a[96:99], v[96:99], v[64:79]
    ds_read_b128 v[120:123], v203 offset:768
    s_mov_b32 s57, 40960
    s_cmp_eq_u32 s51, 2
    s_cselect_b32 s57, 32768, s57
    s_add_u32 s57, s57, s68
    buffer_load_dwordx4 a[160:163], v189, s[36:39], s57 offen offset:0 sc1
    v_mfma_f32_32x32x16_bf16 v[80:95], a[96:99], v[100:103], v[80:95]
    ds_read_b128 v[124:127], v203 offset:33536
    v_lshlrev_b32 v242, 16, v217
    v_and_b32 v243, 0xffff0000, v217
    s_waitcnt vmcnt(11) lgkmcnt(4)
    v_mfma_f32_32x32x16_bf16 v[64:79], a[100:103], v[104:107], v[64:79]
    ds_read_b128 v[96:99], v204 offset:768
    buffer_load_dwordx4 a[164:167], v189, s[36:39], s57 offen offset:1024 sc1
    v_mfma_f32_32x32x16_bf16 v[80:95], a[100:103], v[108:111], v[80:95]
    ds_read_b128 v[100:103], v204 offset:33536
    v_mul_f32_e64 v242, v242, v28
    v_mul_f32 v243, v243, v29
    v_cvt_pk_bf16_f32 v243, v242, v243
    s_waitcnt vmcnt(11) lgkmcnt(4)
    v_mfma_f32_32x32x16_bf16 v[64:79], a[104:107], v[112:115], v[64:79]
    ds_read_b128 v[104:107], v205 offset:768
    buffer_load_dwordx4 a[168:171], v189, s[36:39], s57 offen offset:2048 sc1
    v_mfma_f32_32x32x16_bf16 v[80:95], a[104:107], v[116:119], v[80:95]
    ds_read_b128 v[108:111], v205 offset:33536
    v_lshlrev_b32 v242, 16, v243
    v_and_b32 v243, 0xffff0000, v243
    s_waitcnt vmcnt(11) lgkmcnt(4)
    v_mfma_f32_32x32x16_bf16 v[64:79], a[108:111], v[120:123], v[64:79]
    ds_read_b128 v[112:115], v206 offset:768
    buffer_load_dwordx4 a[172:175], v189, s[36:39], s57 offen offset:3072 sc1
    v_mfma_f32_32x32x16_bf16 v[80:95], a[108:111], v[124:127], v[80:95]
    ds_read_b128 v[116:119], v206 offset:33536
    v_lshlrev_b32 v244, 16, v218
    v_and_b32 v245, 0xffff0000, v218
    s_waitcnt vmcnt(11) lgkmcnt(4)
    v_mfma_f32_32x32x16_bf16 v[64:79], a[112:115], v[96:99], v[64:79]
    ds_read_b128 v[120:123], v207 offset:768
    s_mov_b32 s57, 45056
    s_cmp_eq_u32 s51, 3
    s_cselect_b32 s57, 32768, s57
    s_add_u32 s57, s57, s68
    buffer_load_dwordx4 a[176:179], v189, s[36:39], s57 offen offset:0 sc1
    v_mfma_f32_32x32x16_bf16 v[80:95], a[112:115], v[100:103], v[80:95]
    ds_read_b128 v[124:127], v207 offset:33536
    v_mul_f32_e64 v244, v244, v28
    v_mul_f32 v245, v245, v29
    v_cvt_pk_bf16_f32 v245, v244, v245
    s_waitcnt vmcnt(11) lgkmcnt(4)
    v_mfma_f32_32x32x16_bf16 v[64:79], a[116:119], v[104:107], v[64:79]
    v_subrev_u32 v200, 98304, v200
    ds_read_b128 v[96:99], v200 offset:0
    buffer_load_dwordx4 a[180:183], v189, s[36:39], s57 offen offset:1024 sc1
    v_mfma_f32_32x32x16_bf16 v[80:95], a[116:119], v[108:111], v[80:95]
    ds_read_b128 v[100:103], v200 offset:32768
    v_lshlrev_b32 v244, 16, v245
    v_and_b32 v245, 0xffff0000, v245
    s_waitcnt vmcnt(11) lgkmcnt(4)
    v_mfma_f32_32x32x16_bf16 v[64:79], a[120:123], v[112:115], v[64:79]
    v_subrev_u32 v201, 98304, v201
    ds_read_b128 v[104:107], v201 offset:0
    buffer_load_dwordx4 a[184:187], v189, s[36:39], s57 offen offset:2048 sc1
    v_mfma_f32_32x32x16_bf16 v[80:95], a[120:123], v[116:119], v[80:95]
    ds_read_b128 v[108:111], v201 offset:32768
    v_lshlrev_b32 v246, 16, v219
    v_and_b32 v247, 0xffff0000, v219
    s_waitcnt vmcnt(11) lgkmcnt(4)
    v_mfma_f32_32x32x16_bf16 v[64:79], a[124:127], v[120:123], v[64:79]
    v_subrev_u32 v202, 98304, v202
    ds_read_b128 v[112:115], v202 offset:0
    buffer_load_dwordx4 a[188:191], v189, s[36:39], s57 offen offset:3072 sc1
    v_mfma_f32_32x32x16_bf16 v[80:95], a[124:127], v[124:127], v[80:95]
    ds_read_b128 v[116:119], v202 offset:32768
    v_mul_f32_e64 v246, v246, v28
    v_mul_f32 v247, v247, v29
    v_cvt_pk_bf16_f32 v247, v246, v247
    s_waitcnt lgkmcnt(4)
    v_mfma_f32_32x32x16_bf16 v[64:79], a[128:131], v[96:99], v[64:79]
    v_subrev_u32 v203, 98304, v203
    ds_read_b128 v[120:123], v203 offset:0
    v_lshlrev_b32_e64 v246, 16, v247
    v_and_b32 v247, 0xffff0000, v247
    v_mfma_f32_32x32x16_bf16 v[80:95], a[128:131], v[100:103], v[80:95]
    ds_read_b128 v[124:127], v203 offset:32768
    v_lshlrev_b32 v248, 16, v220
    v_and_b32 v249, 0xffff0000, v220
    s_waitcnt lgkmcnt(4)
    v_mfma_f32_32x32x16_bf16 v[64:79], a[132:135], v[104:107], v[64:79]
    v_subrev_u32 v204, 98304, v204
    ds_read_b128 v[96:99], v204 offset:0
    v_mul_f32 v248, v248, v28
    v_mul_f32 v249, v249, v29
    v_cvt_pk_bf16_f32 v249, v248, v249
    v_mfma_f32_32x32x16_bf16 v[80:95], a[132:135], v[108:111], v[80:95]
    ds_read_b128 v[100:103], v204 offset:32768
    v_lshlrev_b32 v248, 16, v249
    v_and_b32 v249, 0xffff0000, v249
    s_waitcnt lgkmcnt(4)
    v_mfma_f32_32x32x16_bf16 v[64:79], a[136:139], v[112:115], v[64:79]
    v_subrev_u32 v205, 98304, v205
    ds_read_b128 v[104:107], v205 offset:0
    v_lshlrev_b32_e64 v250, 16, v221
    v_and_b32 v251, 0xffff0000, v221
    v_mfma_f32_32x32x16_bf16 v[80:95], a[136:139], v[116:119], v[80:95]
    ds_read_b128 v[108:111], v205 offset:32768
    v_mul_f32_e64 v250, v250, v28
    v_mul_f32 v251, v251, v29
    v_cvt_pk_bf16_f32 v251, v250, v251
    s_waitcnt lgkmcnt(4)
    v_mfma_f32_32x32x16_bf16 v[64:79], a[140:143], v[120:123], v[64:79]
    v_subrev_u32 v206, 98304, v206
    ds_read_b128 v[112:115], v206 offset:0
    v_lshlrev_b32_e64 v250, 16, v251
    v_and_b32 v251, 0xffff0000, v251
    v_mfma_f32_32x32x16_bf16 v[80:95], a[140:143], v[124:127], v[80:95]
    ds_read_b128 v[116:119], v206 offset:32768
    v_lshlrev_b32 v252, 16, v222
    v_and_b32 v253, 0xffff0000, v222
    s_waitcnt vmcnt(11) lgkmcnt(4)
    v_mfma_f32_32x32x16_bf16 v[64:79], a[144:147], v[96:99], v[64:79]
    v_subrev_u32 v207, 98304, v207
    ds_read_b128 v[120:123], v207 offset:0
    s_mov_b32 s57, 49152
    s_cmp_eq_u32 s51, 4
    s_cselect_b32 s57, 32768, s57
    s_add_u32 s57, s57, s68
    buffer_load_dwordx4 a[192:195], v189, s[36:39], s57 offen offset:0 sc1
    v_mfma_f32_32x32x16_bf16 v[80:95], a[144:147], v[100:103], v[80:95]
    ds_read_b128 v[124:127], v207 offset:32768
    v_mul_f32_e64 v252, v252, v28
    v_mul_f32 v253, v253, v29
    v_cvt_pk_bf16_f32 v253, v252, v253
    s_waitcnt vmcnt(11) lgkmcnt(4)
    v_mfma_f32_32x32x16_bf16 v[64:79], a[148:151], v[104:107], v[64:79]
    ds_read_b128 v[96:99], v200 offset:256
    buffer_load_dwordx4 a[196:199], v189, s[36:39], s57 offen offset:1024 sc1
    v_mfma_f32_32x32x16_bf16 v[80:95], a[148:151], v[108:111], v[80:95]
    ds_read_b128 v[100:103], v200 offset:33024
    v_lshlrev_b32 v252, 16, v253
    v_and_b32 v253, 0xffff0000, v253
    s_waitcnt vmcnt(11) lgkmcnt(4)
    v_mfma_f32_32x32x16_bf16 v[64:79], a[152:155], v[112:115], v[64:79]
    ds_read_b128 v[104:107], v201 offset:256
    buffer_load_dwordx4 a[200:203], v189, s[36:39], s57 offen offset:2048 sc1
    v_mfma_f32_32x32x16_bf16 v[80:95], a[152:155], v[116:119], v[80:95]
    ds_read_b128 v[108:111], v201 offset:33024
    v_lshlrev_b32 v254, 16, v223
    v_and_b32 v255, 0xffff0000, v223
    s_waitcnt vmcnt(11) lgkmcnt(4)
    v_mfma_f32_32x32x16_bf16 v[64:79], a[156:159], v[120:123], v[64:79]
    ds_read_b128 v[112:115], v202 offset:256
    buffer_load_dwordx4 a[204:207], v189, s[36:39], s57 offen offset:3072 sc1
    v_mfma_f32_32x32x16_bf16 v[80:95], a[156:159], v[124:127], v[80:95]
    ds_read_b128 v[116:119], v202 offset:33024
    v_mul_f32_e64 v254, v254, v28
    v_mul_f32 v255, v255, v29
    v_cvt_pk_bf16_f32 v255, v254, v255
    s_waitcnt vmcnt(11) lgkmcnt(4)
    v_mfma_f32_32x32x16_bf16 v[64:79], a[160:163], v[96:99], v[64:79]
    ds_read_b128 v[120:123], v203 offset:256
    s_mov_b32 s57, 53248
    s_cmp_eq_u32 s51, 5
    s_cselect_b32 s57, 32768, s57
    s_add_u32 s57, s57, s68
    buffer_load_dwordx4 a[208:211], v189, s[36:39], s57 offen offset:0 sc1
    v_mfma_f32_32x32x16_bf16 v[80:95], a[160:163], v[100:103], v[80:95]
    ds_read_b128 v[124:127], v203 offset:33024
    v_lshlrev_b32 v254, 16, v255
    v_and_b32 v255, 0xffff0000, v255
    s_waitcnt vmcnt(11) lgkmcnt(4)
    v_mfma_f32_32x32x16_bf16 v[64:79], a[164:167], v[104:107], v[64:79]
    ds_read_b128 v[96:99], v204 offset:256
    buffer_load_dwordx4 a[212:215], v189, s[36:39], s57 offen offset:1024 sc1
    v_mfma_f32_32x32x16_bf16 v[80:95], a[164:167], v[108:111], v[80:95]
    ds_read_b128 v[100:103], v204 offset:33024
    s_waitcnt vmcnt(11) lgkmcnt(4)
    v_mfma_f32_32x32x16_bf16 v[64:79], a[168:171], v[112:115], v[64:79]
    ds_read_b128 v[104:107], v205 offset:256
    buffer_load_dwordx4 a[216:219], v189, s[36:39], s57 offen offset:2048 sc1
    v_mfma_f32_32x32x16_bf16 v[80:95], a[168:171], v[116:119], v[80:95]
    ds_read_b128 v[108:111], v205 offset:33024
    s_waitcnt vmcnt(11) lgkmcnt(4)
    v_mfma_f32_32x32x16_bf16 v[64:79], a[172:175], v[120:123], v[64:79]
    ds_read_b128 v[112:115], v206 offset:256
    buffer_load_dwordx4 a[220:223], v189, s[36:39], s57 offen offset:3072 sc1
    v_mfma_f32_32x32x16_bf16 v[80:95], a[172:175], v[124:127], v[80:95]
    ds_read_b128 v[116:119], v206 offset:33024
    s_waitcnt vmcnt(11) lgkmcnt(4)
    v_mfma_f32_32x32x16_bf16 v[64:79], a[176:179], v[96:99], v[64:79]
    ds_read_b128 v[120:123], v207 offset:256
    s_mov_b32 s57, 57344
    s_cmp_eq_u32 s51, 6
    s_cselect_b32 s57, 32768, s57
    s_add_u32 s57, s57, s68
    buffer_load_dwordx4 a[224:227], v189, s[36:39], s57 offen offset:0 sc1
    v_mfma_f32_32x32x16_bf16 v[80:95], a[176:179], v[100:103], v[80:95]
    ds_read_b128 v[124:127], v207 offset:33024
    s_waitcnt vmcnt(11) lgkmcnt(4)
    v_mfma_f32_32x32x16_bf16 v[64:79], a[180:183], v[104:107], v[64:79]
    ds_read_b128 v[96:99], v200 offset:512
    buffer_load_dwordx4 a[228:231], v189, s[36:39], s57 offen offset:1024 sc1
    v_mfma_f32_32x32x16_bf16 v[80:95], a[180:183], v[108:111], v[80:95]
    ds_read_b128 v[100:103], v200 offset:33280
    s_waitcnt vmcnt(11) lgkmcnt(4)
    v_mfma_f32_32x32x16_bf16 v[64:79], a[184:187], v[112:115], v[64:79]
    ds_read_b128 v[104:107], v201 offset:512
    buffer_load_dwordx4 a[232:235], v189, s[36:39], s57 offen offset:2048 sc1
    v_mfma_f32_32x32x16_bf16 v[80:95], a[184:187], v[116:119], v[80:95]
    ds_read_b128 v[108:111], v201 offset:33280
    s_waitcnt vmcnt(11) lgkmcnt(4)
    v_mfma_f32_32x32x16_bf16 v[64:79], a[188:191], v[120:123], v[64:79]
    ds_read_b128 v[112:115], v202 offset:512
    buffer_load_dwordx4 a[236:239], v189, s[36:39], s57 offen offset:3072 sc1
    v_mfma_f32_32x32x16_bf16 v[80:95], a[188:191], v[124:127], v[80:95]
    ds_read_b128 v[116:119], v202 offset:33280
    s_waitcnt vmcnt(11) lgkmcnt(4)
    v_mfma_f32_32x32x16_bf16 v[64:79], a[192:195], v[96:99], v[64:79]
    ds_read_b128 v[120:123], v203 offset:512
    s_mov_b32 s57, 61440
    s_cmp_eq_u32 s51, 7
    s_cselect_b32 s57, 32768, s57
    s_add_u32 s57, s57, s68
    buffer_load_dwordx4 a[240:243], v189, s[36:39], s57 offen offset:0 sc1
    v_mfma_f32_32x32x16_bf16 v[80:95], a[192:195], v[100:103], v[80:95]
    ds_read_b128 v[124:127], v203 offset:33280
    s_waitcnt vmcnt(11) lgkmcnt(4)
    v_mfma_f32_32x32x16_bf16 v[64:79], a[196:199], v[104:107], v[64:79]
    ds_read_b128 v[96:99], v204 offset:512
    buffer_load_dwordx4 a[244:247], v189, s[36:39], s57 offen offset:1024 sc1
    v_mfma_f32_32x32x16_bf16 v[80:95], a[196:199], v[108:111], v[80:95]
    ds_read_b128 v[100:103], v204 offset:33280
    s_waitcnt vmcnt(11) lgkmcnt(4)
    v_mfma_f32_32x32x16_bf16 v[64:79], a[200:203], v[112:115], v[64:79]
    ds_read_b128 v[104:107], v205 offset:512
    buffer_load_dwordx4 a[248:251], v189, s[36:39], s57 offen offset:2048 sc1
    v_mfma_f32_32x32x16_bf16 v[80:95], a[200:203], v[116:119], v[80:95]
    ds_read_b128 v[108:111], v205 offset:33280
    s_waitcnt vmcnt(11) lgkmcnt(4)
    v_mfma_f32_32x32x16_bf16 v[64:79], a[204:207], v[120:123], v[64:79]
    ds_read_b128 v[112:115], v206 offset:512
    buffer_load_dwordx4 a[252:255], v189, s[36:39], s57 offen offset:3072 sc1
    v_mfma_f32_32x32x16_bf16 v[80:95], a[204:207], v[124:127], v[80:95]
    ds_read_b128 v[116:119], v206 offset:33280
    s_waitcnt vmcnt(11) lgkmcnt(4)
    v_mfma_f32_32x32x16_bf16 v[64:79], a[208:211], v[96:99], v[64:79]
    ds_read_b128 v[120:123], v207 offset:512
    v_mfma_f32_32x32x16_bf16 v[80:95], a[208:211], v[100:103], v[80:95]
    ds_read_b128 v[124:127], v207 offset:33280
    s_waitcnt vmcnt(10) lgkmcnt(4)
    v_mfma_f32_32x32x16_bf16 v[64:79], a[212:215], v[104:107], v[64:79]
    ds_read_b128 v[96:99], v200 offset:768
    v_mfma_f32_32x32x16_bf16 v[80:95], a[212:215], v[108:111], v[80:95]
    ds_read_b128 v[100:103], v200 offset:33536
    s_waitcnt vmcnt(9) lgkmcnt(4)
    v_mfma_f32_32x32x16_bf16 v[64:79], a[216:219], v[112:115], v[64:79]
    ds_read_b128 v[104:107], v201 offset:768
    v_mfma_f32_32x32x16_bf16 v[80:95], a[216:219], v[116:119], v[80:95]
    ds_read_b128 v[108:111], v201 offset:33536
    s_waitcnt vmcnt(8) lgkmcnt(4)
    v_mfma_f32_32x32x16_bf16 v[64:79], a[220:223], v[120:123], v[64:79]
    ds_read_b128 v[112:115], v202 offset:768
    v_mfma_f32_32x32x16_bf16 v[80:95], a[220:223], v[124:127], v[80:95]
    ds_read_b128 v[116:119], v202 offset:33536
    s_waitcnt vmcnt(7) lgkmcnt(4)
    v_mfma_f32_32x32x16_bf16 v[64:79], a[224:227], v[96:99], v[64:79]
    ds_read_b128 v[120:123], v203 offset:768
    v_mfma_f32_32x32x16_bf16 v[80:95], a[224:227], v[100:103], v[80:95]
    ds_read_b128 v[124:127], v203 offset:33536
    s_waitcnt vmcnt(6) lgkmcnt(4)
    v_mfma_f32_32x32x16_bf16 v[64:79], a[228:231], v[104:107], v[64:79]
    ds_read_b128 v[96:99], v204 offset:768
    v_mfma_f32_32x32x16_bf16 v[80:95], a[228:231], v[108:111], v[80:95]
    ds_read_b128 v[100:103], v204 offset:33536
    s_waitcnt vmcnt(5) lgkmcnt(4)
    v_mfma_f32_32x32x16_bf16 v[64:79], a[232:235], v[112:115], v[64:79]
    ds_read_b128 v[104:107], v205 offset:768
    v_mfma_f32_32x32x16_bf16 v[80:95], a[232:235], v[116:119], v[80:95]
    ds_read_b128 v[108:111], v205 offset:33536
    s_waitcnt vmcnt(4) lgkmcnt(4)
    v_mfma_f32_32x32x16_bf16 v[64:79], a[236:239], v[120:123], v[64:79]
    ds_read_b128 v[112:115], v206 offset:768
    v_mfma_f32_32x32x16_bf16 v[80:95], a[236:239], v[124:127], v[80:95]
    ds_read_b128 v[116:119], v206 offset:33536
    s_waitcnt vmcnt(3) lgkmcnt(4)
    v_mfma_f32_32x32x16_bf16 v[64:79], a[240:243], v[96:99], v[64:79]
    ds_read_b128 v[120:123], v207 offset:768
    v_mfma_f32_32x32x16_bf16 v[80:95], a[240:243], v[100:103], v[80:95]
    ds_read_b128 v[124:127], v207 offset:33536
    s_waitcnt vmcnt(2) lgkmcnt(4)
    v_mfma_f32_32x32x16_bf16 v[64:79], a[244:247], v[104:107], v[64:79]
    v_mfma_f32_32x32x16_bf16 v[80:95], a[244:247], v[108:111], v[80:95]
    s_waitcnt vmcnt(1) lgkmcnt(2)
    v_mfma_f32_32x32x16_bf16 v[64:79], a[248:251], v[112:115], v[64:79]
    v_mfma_f32_32x32x16_bf16 v[80:95], a[248:251], v[116:119], v[80:95]
    s_waitcnt vmcnt(0) lgkmcnt(0)
    v_mfma_f32_32x32x16_bf16 v[64:79], a[252:255], v[120:123], v[64:79]
    v_mfma_f32_32x32x16_bf16 v[80:95], a[252:255], v[124:127], v[80:95]
    s_nop 10
    v_add_f32 v224, v224, v64
    v_add_f32 v225, v225, v80
    s_mov_b32 s58, 0
    buffer_store_dwordx2 v[224:225], v192, s[40:43], s58 offen nt
    v_add_f32 v226, v226, v65
    v_add_f32 v227, v227, v81
    s_mov_b32 s58, 4096
    buffer_store_dwordx2 v[226:227], v192, s[40:43], s58 offen nt
    v_add_f32 v228, v228, v66
    v_add_f32 v229, v229, v82
    s_mov_b32 s58, 8192
    buffer_store_dwordx2 v[228:229], v192, s[40:43], s58 offen nt
    v_add_f32 v230, v230, v67
    v_add_f32 v231, v231, v83
    s_mov_b32 s58, 12288
    buffer_store_dwordx2 v[230:231], v192, s[40:43], s58 offen nt
    v_add_f32 v232, v232, v68
    v_add_f32 v233, v233, v84
    s_mov_b32 s58, 65536
    buffer_store_dwordx2 v[232:233], v192, s[40:43], s58 offen nt
    v_add_f32 v234, v234, v69
    v_add_f32 v235, v235, v85
    s_mov_b32 s58, 69632
    buffer_store_dwordx2 v[234:235], v192, s[40:43], s58 offen nt
    v_add_f32 v236, v236, v70
    v_add_f32 v237, v237, v86
    s_mov_b32 s58, 73728
    buffer_store_dwordx2 v[236:237], v192, s[40:43], s58 offen nt
    v_add_f32 v238, v238, v71
    v_add_f32 v239, v239, v87
    s_mov_b32 s58, 77824
    buffer_store_dwordx2 v[238:239], v192, s[40:43], s58 offen nt
    v_add_f32 v240, v240, v72
    v_add_f32 v241, v241, v88
    s_mov_b32 s58, 131072
    buffer_store_dwordx2 v[240:241], v192, s[40:43], s58 offen nt
    v_add_f32 v242, v242, v73
    v_add_f32 v243, v243, v89
    s_mov_b32 s58, 135168
    buffer_store_dwordx2 v[242:243], v192, s[40:43], s58 offen nt
    v_add_f32 v244, v244, v74
    v_add_f32 v245, v245, v90
    s_mov_b32 s58, 139264
    buffer_store_dwordx2 v[244:245], v192, s[40:43], s58 offen nt
    v_add_f32 v246, v246, v75
    v_add_f32 v247, v247, v91
    s_mov_b32 s58, 143360
    buffer_store_dwordx2 v[246:247], v192, s[40:43], s58 offen nt
    v_add_f32 v248, v248, v76
    v_add_f32 v249, v249, v92
    s_mov_b32 s58, 196608
    buffer_store_dwordx2 v[248:249], v192, s[40:43], s58 offen nt
    v_add_f32 v250, v250, v77
    v_add_f32 v251, v251, v93
    s_mov_b32 s58, 200704
    buffer_store_dwordx2 v[250:251], v192, s[40:43], s58 offen nt
    v_add_f32 v252, v252, v78
    v_add_f32 v253, v253, v94
    s_mov_b32 s58, 204800
    buffer_store_dwordx2 v[252:253], v192, s[40:43], s58 offen nt
    v_add_f32 v254, v254, v79
    v_add_f32 v255, v255, v95
    s_mov_b32 s58, 208896
    buffer_store_dwordx2 v[254:255], v192, s[40:43], s58 offen nt
    s_lshl_b32 s48, s50, 5
    s_add_u32 s48, s48, s51
    s_add_u32 s48, s48, s20
    s_cmp_lg_u32 s48, 480
    s_cbranch_scc1 Ltag_21
    v_mov_b32 v2, 9502720
    v_mov_b32_e64 v3, s3
    s_mov_b64 exec, 1
    buffer_store_dword v3, v2, s[36:39], 0 offen sc1
    s_mov_b64 exec, -1
Ltag_21:
    s_endpgm
Lpoll_12:
    buffer_load_dwordx4 v[156:159], v199, s[64:67], 0 offen offset:3072 sc1
    buffer_load_dwordx4 v[152:155], v199, s[64:67], 0 offen offset:2048 sc1
    buffer_load_dwordx4 v[148:151], v199, s[64:67], 0 offen offset:1024 sc1
    buffer_load_dwordx4 v[144:147], v199, s[64:67], 0 offen offset:0 sc1
    buffer_load_dwordx4 v[140:143], v198, s[64:67], 0 offen offset:3072 sc1
    buffer_load_dwordx4 v[136:139], v198, s[64:67], 0 offen offset:2048 sc1
    buffer_load_dwordx4 v[132:135], v198, s[64:67], 0 offen offset:1024 sc1
    buffer_load_dwordx4 v[128:131], v198, s[64:67], 0 offen offset:0 sc1
    s_waitcnt vmcnt(0)
    v_xor_b32 v6, v129, v176
    v_xor_b32 v5, v131, v176
    v_bitop3_b32 v6, v133, v177, v6 bitop3:0xbe
    v_bitop3_b32 v5, v135, v177, v5 bitop3:0xbe
    v_bitop3_b32 v6, v137, v178, v6 bitop3:0xbe
    v_bitop3_b32 v5, v139, v178, v5 bitop3:0xbe
    v_bitop3_b32 v6, v141, v179, v6 bitop3:0xbe
    v_bitop3_b32 v5, v143, v179, v5 bitop3:0xbe
    v_bitop3_b32 v6, v145, v180, v6 bitop3:0xbe
    v_bitop3_b32 v5, v147, v180, v5 bitop3:0xbe
    v_bitop3_b32 v6, v149, v181, v6 bitop3:0xbe
    v_bitop3_b32 v5, v151, v181, v5 bitop3:0xbe
    v_bitop3_b32 v6, v153, v182, v6 bitop3:0xbe
    v_bitop3_b32 v5, v155, v182, v5 bitop3:0xbe
    v_bitop3_b32 v6, v157, v183, v6 bitop3:0xbe
    v_bitop3_b32 v5, v159, v183, v5 bitop3:0xbe
    v_or_b32 v6, v6, v5
    v_cmp_ne_u32 vcc, 0, v6
    s_sub_u32 s59, s59, 1
    s_cbranch_vccz Lpolld_13
    s_cmp_eq_u32 s59, 0
    s_cbranch_scc1 Lpolld_13
    s_branch Lpoll_12
L_codeend:
    s_endpgm
.section .rodata,"a"
.p2align 6
.amdhsa_kernel concat_heads__ssm_conv_s5__linear_kernel_hedgehog__prompt_kernel
  .amdhsa_next_free_vgpr 512
  .amdhsa_next_free_sgpr 102
  .amdhsa_accum_offset 256
  .amdhsa_group_segment_fixed_size 0
  .amdhsa_kernarg_size 128
  .amdhsa_user_sgpr_count 2
  .amdhsa_user_sgpr_kernarg_segment_ptr 1
  .amdhsa_system_sgpr_workgroup_id_x 1
  .amdhsa_float_denorm_mode_32 3
.end_amdhsa_kernel
```
